```python
import torch

def _softmax(x, axis=-1):
    return torch.softmax(x, dim=axis)
def _gelu(x):
    return torch.nn.functional.gelu(x, approximate="tanh")
def _silu(x):
    return torch.nn.functional.silu(x)
def _sigmoid(x):
    return torch.sigmoid(x)
def _layernorm(x, axis=-1, eps=1e-5):
    m = x.mean(dim=axis, keepdim=True)
    v = x.var(dim=axis, keepdim=True, unbiased=False)
    return (x - m) / torch.sqrt(v + eps)
def _scatter_add(tgt, idx, src, axis=0):
    return tgt.clone().index_add_(axis, idx, src)
def _segment_sum(src, seg, n):
    out = torch.zeros((n,) + src.shape[1:], dtype=src.dtype)
    return out.index_add_(0, seg, src)
def _pad(x, pw):
    flat = tuple(v for pair in reversed(pw) for v in pair)
    return torch.nn.functional.pad(x, flat)

kernel_name = 'parallel_sum__grouped_kv_mqa__glu_gated_geglu__prompt'

def setup_inputs():

    _w = (lambda a: (lambda t: t.to(torch.bfloat16) if t.is_floating_point() else t)(torch.as_tensor(a)))
    def _A_setup():
        B, S, D, H = 1, 2048, 512, 32
        Dh = D // H
        return {
            "x": _w((lambda *s: torch.randn(*s, dtype=torch.bfloat16) * 0.05)(B, S, D)),
            "wq": _w((lambda *s: torch.randn(*s, dtype=torch.bfloat16) * 0.05)(D, H * Dh)),
            "wk": _w((lambda *s: torch.randn(*s, dtype=torch.bfloat16) * 0.05)(D, Dh)),
            "wv": _w((lambda *s: torch.randn(*s, dtype=torch.bfloat16) * 0.05)(D, Dh)),
            "wo": _w((lambda *s: torch.randn(*s, dtype=torch.bfloat16) * 0.05)(H * Dh, D)),
        }
    _A_in = _A_setup()

    def _B_setup():
        B, S, Dm, Df = 1, 2048, 512, 1376
        return {
            "x": _w((lambda *s: torch.randn(*s, dtype=torch.bfloat16) * 0.05)(B, S, Dm)),
            "w_gate": _w((lambda *s: torch.randn(*s, dtype=torch.bfloat16) * 0.4)(Dm, Df) * (Dm ** -0.5)),
            "w_up": _w((lambda *s: torch.randn(*s, dtype=torch.bfloat16) * 0.4)(Dm, Df) * (Dm ** -0.5)),
            "w_down": _w((lambda *s: torch.randn(*s, dtype=torch.bfloat16) * 0.4)(Df, Dm) * (Df ** -0.5)),
        }
    _B_in = _B_setup()

    return {
        "A_x": _A_in["x"],
        "A_wq": _A_in["wq"],
        "A_wk": _A_in["wk"],
        "A_wv": _A_in["wv"],
        "A_wo": _A_in["wo"],
        "B_x": _B_in["x"],
        "B_w_gate": _B_in["w_gate"],
        "B_w_up": _B_in["w_up"],
        "B_w_down": _B_in["w_down"],
    }

def reference(A_x, A_wq, A_wk, A_wv, A_wo, B_x, B_w_gate, B_w_up, B_w_down):
    def _A_ref(x, wq, wk, wv, wo):
        B, S, D = x.shape
        H = 32
        Dh = D // H
        q = (lambda x, *d: x.permute(*d))((x @ wq).reshape(B, S, H, Dh), 0, 2, 1, 3)
        k = x @ wk
        v = x @ wv
        scores = torch.einsum("bhqd,bkd->bhqk", q, k) * (Dh ** -0.5)
        p = _softmax(scores, axis=-1)
        o = torch.einsum("bhqk,bkd->bhqd", p, v)
        return (lambda x, *d: x.permute(*d))(o, 0, 2, 1, 3).reshape(B, S, H * Dh) @ wo

    def _B_ref(x, w_gate, w_up, w_down):
        g = torch.einsum("bsd,df->bsf", x, w_gate)
        u = torch.einsum("bsd,df->bsf", x, w_up)
        h = _gelu(g) * u
        return torch.einsum("bsf,fd->bsd", h, w_down)

    x = A_x
    xn = _layernorm(x, axis=-1)
    return x + _A_ref(xn, A_wq, A_wk, A_wv, A_wo) + _B_ref(xn, B_w_gate, B_w_up, B_w_down)
```

```asm
; @launch kernel=prep_kernel grid=(256,1,1) block=(512,1,1) lds=143872
; @launch kernel=main_kernel grid=(256,1,1) block=(512,1,1) lds=163840
.amdgcn_target "amdgcn-amd-amdhsa--gfx950"
.text
.globl prep_kernel
.p2align 8
.type prep_kernel,@function
prep_kernel:
s_cmp_ge_u32 s2, 256
s_cbranch_scc1 K1_END
s_load_dwordx4 s[4:7], s[0:1], 0
s_load_dwordx4 s[8:11], s[0:1], 16
s_load_dwordx2 s[12:13], s[0:1], 32
s_load_dwordx4 s[16:19], s[0:1], 48
s_load_dwordx2 s[20:21], s[0:1], 64
s_load_dwordx2 s[22:23], s[0:1], 88
v_lshrrev_b32 v1, 6, v0
v_and_b32 v0, 63, v0
s_nop 0
v_readfirstlane_b32 s24, v1
s_lshr_b32 s25, s2, 2
s_and_b32 s26, s2, 3
v_and_b32 v2, 31, v0
v_lshrrev_b32 v3, 5, v0
v_lshlrev_b32 v4, 10, v2
v_lshl_add_u32 v4, v3, 4, v4
s_lshl_b32 s27, s25, 15
s_lshl_b32 s28, s24, 7
s_add_u32 s27, s27, s28
v_lshrrev_b32 v5, 2, v0
v_and_b32 v6, 3, v0
v_lshlrev_b32 v9, 4, v0
s_waitcnt lgkmcnt(0)
s_mov_b32 s32, s4
s_mov_b32 s33, s5
s_mov_b32 s34, 2097152
s_mov_b32 s35, 0x00020000
s_mov_b32 s36, s22
s_mov_b32 s37, s23
s_mov_b32 s38, 33554432
s_mov_b32 s39, 0x00020000
buffer_load_dwordx4 v[16:19], v4, s[32:35], s27 offen offset:0
buffer_load_dwordx4 v[20:23], v4, s[32:35], s27 offen offset:32
buffer_load_dwordx4 v[24:27], v4, s[32:35], s27 offen offset:64
buffer_load_dwordx4 v[28:31], v4, s[32:35], s27 offen offset:96
v_and_b32 v10, 15, v0
v_lshrrev_b32 v11, 2, v10
v_lshlrev_b32 v11, 6, v11
v_and_b32 v10, 3, v0
v_lshl_add_u32 v11, v10, 3, v11
v_bfe_u32 v10, v0, 4, 1
v_lshl_add_u32 v11, v10, 5, v11
v_lshl_add_u32 v7, v3, 9, v11
v_lshl_add_u32 v8, v3, 8, v11
s_mov_b32 s59, 0
s_barrier
s_cmp_ge_u32 s24, 5
s_cbranch_scc1 K1_PP
s_cmp_eq_u32 s24, 4
s_cbranch_scc1 K1_KVSET
s_mov_b32 s40, s6
s_mov_b32 s41, s7
s_mov_b32 s42, 524288
s_mov_b32 s43, 0x00020000
s_lshl_b32 s29, s26, 2
s_add_u32 s29, s29, s24
s_lshl_b32 s30, s29, 6
v_lshlrev_b32 v12, 10, v5
v_lshl_add_u32 v12, v6, 4, v12
v_add_u32 v12, s30, v12
v_lshrrev_b32 v12, 3, v0
v_lshlrev_b32 v12, 10, v12
v_and_b32 v10, 7, v0
v_lshl_add_u32 v12, v10, 4, v12
s_and_b32 s30, s29, 14
s_lshl_b32 s30, s30, 6
s_and_b32 s31, s29, 1
s_lshl_b32 s31, s31, 13
s_add_u32 s30, s30, s31
v_add_u32 v12, s30, v12
s_mov_b32 s31, 16384
s_mov_b32 s59, 1
s_lshr_b32 s44, s24, 1
s_lshl_b32 s44, s44, 15
s_add_u32 s44, s44, 32768
s_and_b32 s57, s24, 1
v_and_b32 v13, 12, v0
v_lshlrev_b32 v13, 5, v13
v_lshl_add_u32 v13, v6, 3, v13
v_bfe_u32 v10, v0, 4, 1
v_lshl_add_u32 v13, v10, 5, v13
v_lshl_add_u32 v13, v3, 10, v13
s_lshl_b32 s58, s57, 6
s_add_u32 s58, s58, s44
v_add_u32 v13, s58, v13
s_lshl_b32 s57, s57, 10
s_add_u32 s44, s44, s57
s_mov_b32 s58, 2048
s_branch K1_WLOAD
K1_KVSET:
s_cmp_ge_u32 s26, 2
s_cbranch_scc1 K1_LN
s_cmp_eq_u32 s26, 0
s_cselect_b32 s40, s8, s10
s_cselect_b32 s41, s9, s11
s_mov_b32 s42, 16384
s_mov_b32 s43, 0x00020000
v_lshlrev_b32 v12, 5, v5
v_and_b32 v10, 1, v0
v_lshl_add_u32 v12, v10, 4, v12
s_mov_b32 s31, 512
s_mov_b32 s59, 1
s_lshl_b32 s44, s24, 14
s_add_u32 s44, s44, 32768
v_add_u32 v13, s44, v7
s_mov_b32 s58, 1024
K1_WLOAD:
s_mov_b32 s45, 0
s_mov_b32 m0, s44
s_nop 0
buffer_load_dwordx4 v12, s[40:43], s45 offen lds
s_add_u32 s45, s45, s31
s_add_u32 m0, m0, s58
s_nop 0
buffer_load_dwordx4 v12, s[40:43], s45 offen lds
s_add_u32 s45, s45, s31
s_add_u32 m0, m0, s58
s_nop 0
buffer_load_dwordx4 v12, s[40:43], s45 offen lds
s_add_u32 s45, s45, s31
s_add_u32 m0, m0, s58
s_nop 0
buffer_load_dwordx4 v12, s[40:43], s45 offen lds
s_add_u32 s45, s45, s31
s_add_u32 m0, m0, s58
s_nop 0
buffer_load_dwordx4 v12, s[40:43], s45 offen lds
s_add_u32 s45, s45, s31
s_add_u32 m0, m0, s58
s_nop 0
buffer_load_dwordx4 v12, s[40:43], s45 offen lds
s_add_u32 s45, s45, s31
s_add_u32 m0, m0, s58
s_nop 0
buffer_load_dwordx4 v12, s[40:43], s45 offen lds
s_add_u32 s45, s45, s31
s_add_u32 m0, m0, s58
s_nop 0
buffer_load_dwordx4 v12, s[40:43], s45 offen lds
s_add_u32 s45, s45, s31
s_add_u32 m0, m0, s58
s_nop 0
buffer_load_dwordx4 v12, s[40:43], s45 offen lds
s_add_u32 s45, s45, s31
s_add_u32 m0, m0, s58
s_nop 0
buffer_load_dwordx4 v12, s[40:43], s45 offen lds
s_add_u32 s45, s45, s31
s_add_u32 m0, m0, s58
s_nop 0
buffer_load_dwordx4 v12, s[40:43], s45 offen lds
s_add_u32 s45, s45, s31
s_add_u32 m0, m0, s58
s_nop 0
buffer_load_dwordx4 v12, s[40:43], s45 offen lds
s_add_u32 s45, s45, s31
s_add_u32 m0, m0, s58
s_nop 0
buffer_load_dwordx4 v12, s[40:43], s45 offen lds
s_add_u32 s45, s45, s31
s_add_u32 m0, m0, s58
s_nop 0
buffer_load_dwordx4 v12, s[40:43], s45 offen lds
s_add_u32 s45, s45, s31
s_add_u32 m0, m0, s58
s_nop 0
buffer_load_dwordx4 v12, s[40:43], s45 offen lds
s_add_u32 s45, s45, s31
s_add_u32 m0, m0, s58
s_nop 0
buffer_load_dwordx4 v12, s[40:43], s45 offen lds
s_add_u32 s45, s45, s31
s_add_u32 m0, m0, s58
s_waitcnt vmcnt(16)
s_branch K1_LN2
K1_PP:
s_mul_i32 s46, s2, 3
s_add_u32 s46, s46, s24
s_sub_u32 s46, s46, 5
s_cmp_ge_u32 s46, 580
s_cbranch_scc1 K1_LN
s_mov_b32 s59, 2
s_cmp_ge_u32 s46, 344
s_cbranch_scc1 K1_PPD
s_cmp_ge_u32 s46, 172
s_cselect_b32 s40, s18, s16
s_cselect_b32 s41, s19, s17
s_cselect_b32 s47, 172, 0
s_cselect_b32 s48, 1024, 0
s_mov_b32 s42, 1409024
s_mov_b32 s43, 0x00020000
s_sub_u32 s46, s46, s47
s_lshr_b32 s47, s46, 2
s_and_b32 s46, s46, 3
s_mov_b32 s49, 2752
v_mul_lo_u32 v12, s49, v5
v_lshl_add_u32 v12, v6, 4, v12
s_mul_i32 s45, s46, 352256
s_lshl_b32 s49, s47, 6
s_add_u32 s45, s45, s49
s_mov_b32 s31, 44032
s_lshl_b32 s50, s47, 16
s_lshl_b32 s49, s46, 14
s_add_u32 s50, s50, s49
s_add_u32 s50, s50, s48
s_add_u32 s50, s50, 5242880
s_mov_b32 s51, 8192
s_mov_b32 s52, 2048
s_mov_b32 s53, 256
v_mov_b32 v13, v7
s_branch K1_PPL
K1_PPD:
s_cmp_ge_u32 s46, 516
s_cselect_b32 s40, s12, s20
s_cselect_b32 s41, s13, s21
s_mov_b32 s42, 1409024
s_cselect_b32 s42, 524288, s42
s_mov_b32 s47, 344
s_cselect_b32 s47, 516, s47
s_mov_b32 s51, 352256
s_cselect_b32 s51, 131072, s51
s_mov_b32 s50, 8388608
s_cselect_b32 s50, 10485760, s50
s_mov_b32 s43, 0x00020000
s_sub_u32 s46, s46, s47
s_lshr_b32 s47, s46, 1
s_and_b32 s46, s46, 1
v_lshlrev_b32 v12, 10, v5
v_lshl_add_u32 v12, v6, 4, v12
s_lshl_b32 s45, s47, 14
s_lshl_b32 s49, s46, 9
s_add_u32 s45, s45, s49
s_mov_b32 s31, 64
s_lshl_b32 s49, s47, 12
s_add_u32 s50, s50, s49
s_mul_i32 s49, s46, s51
s_lshl_b32 s49, s49, 1
s_add_u32 s50, s50, s49
s_mov_b32 s52, 1024
s_mov_b32 s53, 512
v_mov_b32 v13, v8
K1_PPL:
s_sub_u32 s44, s24, 5
s_lshl_b32 s44, s44, 13
s_add_u32 s44, s44, 114688
v_add_u32 v13, s44, v13
v_add_u32 v14, s53, v13
s_mov_b32 m0, s44
s_nop 0
buffer_load_dwordx4 v12, s[40:43], s45 offen lds
s_add_u32 s45, s45, s31
s_add_u32 m0, m0, 1024
s_nop 0
buffer_load_dwordx4 v12, s[40:43], s45 offen lds
s_add_u32 s45, s45, s31
s_add_u32 m0, m0, 1024
s_nop 0
buffer_load_dwordx4 v12, s[40:43], s45 offen lds
s_add_u32 s45, s45, s31
s_add_u32 m0, m0, 1024
s_nop 0
buffer_load_dwordx4 v12, s[40:43], s45 offen lds
s_add_u32 s45, s45, s31
s_add_u32 m0, m0, 1024
s_nop 0
buffer_load_dwordx4 v12, s[40:43], s45 offen lds
s_add_u32 s45, s45, s31
s_add_u32 m0, m0, 1024
s_nop 0
buffer_load_dwordx4 v12, s[40:43], s45 offen lds
s_add_u32 s45, s45, s31
s_add_u32 m0, m0, 1024
s_nop 0
buffer_load_dwordx4 v12, s[40:43], s45 offen lds
s_add_u32 s45, s45, s31
s_add_u32 m0, m0, 1024
s_nop 0
buffer_load_dwordx4 v12, s[40:43], s45 offen lds
s_add_u32 s45, s45, s31
s_add_u32 m0, m0, 1024
s_waitcnt vmcnt(8)
s_branch K1_LN2
K1_LN:
s_waitcnt vmcnt(0)
K1_LN2:
v_lshlrev_b32 v32, 16, v16
v_and_b32 v33, 0xffff0000, v16
v_lshlrev_b32 v34, 16, v17
v_and_b32 v35, 0xffff0000, v17
v_lshlrev_b32 v36, 16, v18
v_and_b32 v37, 0xffff0000, v18
v_lshlrev_b32 v38, 16, v19
v_and_b32 v39, 0xffff0000, v19
v_lshlrev_b32 v40, 16, v20
v_and_b32 v41, 0xffff0000, v20
v_lshlrev_b32 v42, 16, v21
v_and_b32 v43, 0xffff0000, v21
v_lshlrev_b32 v44, 16, v22
v_and_b32 v45, 0xffff0000, v22
v_lshlrev_b32 v46, 16, v23
v_and_b32 v47, 0xffff0000, v23
v_lshlrev_b32 v48, 16, v24
v_and_b32 v49, 0xffff0000, v24
v_lshlrev_b32 v50, 16, v25
v_and_b32 v51, 0xffff0000, v25
v_lshlrev_b32 v52, 16, v26
v_and_b32 v53, 0xffff0000, v26
v_lshlrev_b32 v54, 16, v27
v_and_b32 v55, 0xffff0000, v27
v_lshlrev_b32 v56, 16, v28
v_and_b32 v57, 0xffff0000, v28
v_lshlrev_b32 v58, 16, v29
v_and_b32 v59, 0xffff0000, v29
v_lshlrev_b32 v60, 16, v30
v_and_b32 v61, 0xffff0000, v30
v_lshlrev_b32 v62, 16, v31
v_and_b32 v63, 0xffff0000, v31
v_add_f32 v64, v32, v33
v_add_f32 v65, v34, v35
v_add_f32 v64, v64, v36
v_add_f32 v65, v65, v37
v_add_f32 v64, v64, v38
v_add_f32 v65, v65, v39
v_add_f32 v64, v64, v40
v_add_f32 v65, v65, v41
v_add_f32 v64, v64, v42
v_add_f32 v65, v65, v43
v_add_f32 v64, v64, v44
v_add_f32 v65, v65, v45
v_add_f32 v64, v64, v46
v_add_f32 v65, v65, v47
v_add_f32 v64, v64, v48
v_add_f32 v65, v65, v49
v_add_f32 v64, v64, v50
v_add_f32 v65, v65, v51
v_add_f32 v64, v64, v52
v_add_f32 v65, v65, v53
v_add_f32 v64, v64, v54
v_add_f32 v65, v65, v55
v_add_f32 v64, v64, v56
v_add_f32 v65, v65, v57
v_add_f32 v64, v64, v58
v_add_f32 v65, v65, v59
v_add_f32 v64, v64, v60
v_add_f32 v65, v65, v61
v_add_f32 v64, v64, v62
v_add_f32 v65, v65, v63
v_add_f32 v64, v64, v65
v_mul_f32 v64, 0x3d000000, v64
v_mov_b32 v65, 0
v_mov_b32 v66, 0
v_sub_f32 v67, v32, v64
v_sub_f32 v68, v33, v64
v_fmac_f32 v65, v67, v67
v_fmac_f32 v66, v68, v68
v_sub_f32 v67, v34, v64
v_sub_f32 v68, v35, v64
v_fmac_f32 v65, v67, v67
v_fmac_f32 v66, v68, v68
v_sub_f32 v67, v36, v64
v_sub_f32 v68, v37, v64
v_fmac_f32 v65, v67, v67
v_fmac_f32 v66, v68, v68
v_sub_f32 v67, v38, v64
v_sub_f32 v68, v39, v64
v_fmac_f32 v65, v67, v67
v_fmac_f32 v66, v68, v68
v_sub_f32 v67, v40, v64
v_sub_f32 v68, v41, v64
v_fmac_f32 v65, v67, v67
v_fmac_f32 v66, v68, v68
v_sub_f32 v67, v42, v64
v_sub_f32 v68, v43, v64
v_fmac_f32 v65, v67, v67
v_fmac_f32 v66, v68, v68
v_sub_f32 v67, v44, v64
v_sub_f32 v68, v45, v64
v_fmac_f32 v65, v67, v67
v_fmac_f32 v66, v68, v68
v_sub_f32 v67, v46, v64
v_sub_f32 v68, v47, v64
v_fmac_f32 v65, v67, v67
v_fmac_f32 v66, v68, v68
v_sub_f32 v67, v48, v64
v_sub_f32 v68, v49, v64
v_fmac_f32 v65, v67, v67
v_fmac_f32 v66, v68, v68
v_sub_f32 v67, v50, v64
v_sub_f32 v68, v51, v64
v_fmac_f32 v65, v67, v67
v_fmac_f32 v66, v68, v68
v_sub_f32 v67, v52, v64
v_sub_f32 v68, v53, v64
v_fmac_f32 v65, v67, v67
v_fmac_f32 v66, v68, v68
v_sub_f32 v67, v54, v64
v_sub_f32 v68, v55, v64
v_fmac_f32 v65, v67, v67
v_fmac_f32 v66, v68, v68
v_sub_f32 v67, v56, v64
v_sub_f32 v68, v57, v64
v_fmac_f32 v65, v67, v67
v_fmac_f32 v66, v68, v68
v_sub_f32 v67, v58, v64
v_sub_f32 v68, v59, v64
v_fmac_f32 v65, v67, v67
v_fmac_f32 v66, v68, v68
v_sub_f32 v67, v60, v64
v_sub_f32 v68, v61, v64
v_fmac_f32 v65, v67, v67
v_fmac_f32 v66, v68, v68
v_sub_f32 v67, v62, v64
v_sub_f32 v68, v63, v64
v_fmac_f32 v65, v67, v67
v_fmac_f32 v66, v68, v68
v_add_f32 v65, v65, v66
v_mul_u32_u24 v66, 144, v2
v_add_u32 v66, 139264, v66
s_lshl_b32 s54, s24, 4
v_lshl_add_u32 v67, v3, 3, v66
v_add_u32 v67, s54, v67
ds_write_b64 v67, v[64:65]
s_cmp_eq_u32 s59, 1
s_cbranch_scc0 K1_NW1
s_waitcnt vmcnt(0)
K1_NW1:
s_waitcnt lgkmcnt(0)
s_barrier
s_cmp_eq_u32 s59, 1
s_cbranch_scc0 K1_NW3
s_cmp_eq_u32 s24, 4
s_cbranch_scc1 K1_TA0
ds_read_b64_tr_b16 v[128:129], v13 offset:0
ds_read_b64_tr_b16 v[130:131], v13 offset:512
ds_read_b64_tr_b16 v[132:133], v13 offset:2048
ds_read_b64_tr_b16 v[134:135], v13 offset:2560
ds_read_b64_tr_b16 v[136:137], v13 offset:4096
ds_read_b64_tr_b16 v[138:139], v13 offset:4608
ds_read_b64_tr_b16 v[140:141], v13 offset:6144
ds_read_b64_tr_b16 v[142:143], v13 offset:6656
ds_read_b64_tr_b16 v[144:145], v13 offset:8192
ds_read_b64_tr_b16 v[146:147], v13 offset:8704
ds_read_b64_tr_b16 v[148:149], v13 offset:10240
ds_read_b64_tr_b16 v[150:151], v13 offset:10752
ds_read_b64_tr_b16 v[152:153], v13 offset:12288
ds_read_b64_tr_b16 v[154:155], v13 offset:12800
ds_read_b64_tr_b16 v[156:157], v13 offset:14336
ds_read_b64_tr_b16 v[158:159], v13 offset:14848
ds_read_b64_tr_b16 v[160:161], v13 offset:16384
ds_read_b64_tr_b16 v[162:163], v13 offset:16896
ds_read_b64_tr_b16 v[164:165], v13 offset:18432
ds_read_b64_tr_b16 v[166:167], v13 offset:18944
ds_read_b64_tr_b16 v[168:169], v13 offset:20480
ds_read_b64_tr_b16 v[170:171], v13 offset:20992
ds_read_b64_tr_b16 v[172:173], v13 offset:22528
ds_read_b64_tr_b16 v[174:175], v13 offset:23040
ds_read_b64_tr_b16 v[176:177], v13 offset:24576
ds_read_b64_tr_b16 v[178:179], v13 offset:25088
ds_read_b64_tr_b16 v[180:181], v13 offset:26624
ds_read_b64_tr_b16 v[182:183], v13 offset:27136
ds_read_b64_tr_b16 v[184:185], v13 offset:28672
ds_read_b64_tr_b16 v[186:187], v13 offset:29184
ds_read_b64_tr_b16 v[188:189], v13 offset:30720
ds_read_b64_tr_b16 v[190:191], v13 offset:31232
s_branch K1_TB0
K1_TA0:
ds_read_b64_tr_b16 v[128:129], v13 offset:0
ds_read_b64_tr_b16 v[130:131], v13 offset:256
ds_read_b64_tr_b16 v[132:133], v13 offset:1024
ds_read_b64_tr_b16 v[134:135], v13 offset:1280
ds_read_b64_tr_b16 v[136:137], v13 offset:2048
ds_read_b64_tr_b16 v[138:139], v13 offset:2304
ds_read_b64_tr_b16 v[140:141], v13 offset:3072
ds_read_b64_tr_b16 v[142:143], v13 offset:3328
ds_read_b64_tr_b16 v[144:145], v13 offset:4096
ds_read_b64_tr_b16 v[146:147], v13 offset:4352
ds_read_b64_tr_b16 v[148:149], v13 offset:5120
ds_read_b64_tr_b16 v[150:151], v13 offset:5376
ds_read_b64_tr_b16 v[152:153], v13 offset:6144
ds_read_b64_tr_b16 v[154:155], v13 offset:6400
ds_read_b64_tr_b16 v[156:157], v13 offset:7168
ds_read_b64_tr_b16 v[158:159], v13 offset:7424
ds_read_b64_tr_b16 v[160:161], v13 offset:8192
ds_read_b64_tr_b16 v[162:163], v13 offset:8448
ds_read_b64_tr_b16 v[164:165], v13 offset:9216
ds_read_b64_tr_b16 v[166:167], v13 offset:9472
ds_read_b64_tr_b16 v[168:169], v13 offset:10240
ds_read_b64_tr_b16 v[170:171], v13 offset:10496
ds_read_b64_tr_b16 v[172:173], v13 offset:11264
ds_read_b64_tr_b16 v[174:175], v13 offset:11520
ds_read_b64_tr_b16 v[176:177], v13 offset:12288
ds_read_b64_tr_b16 v[178:179], v13 offset:12544
ds_read_b64_tr_b16 v[180:181], v13 offset:13312
ds_read_b64_tr_b16 v[182:183], v13 offset:13568
ds_read_b64_tr_b16 v[184:185], v13 offset:14336
ds_read_b64_tr_b16 v[186:187], v13 offset:14592
ds_read_b64_tr_b16 v[188:189], v13 offset:15360
ds_read_b64_tr_b16 v[190:191], v13 offset:15616
K1_TB0:
s_waitcnt lgkmcnt(0)
K1_NW3:
s_cmp_eq_u32 s59, 1
s_cselect_b64 vcc, -1, 0
s_mov_b32 m0, s44
s_barrier
s_cbranch_vccz K1_WS1
buffer_load_dwordx4 v12, s[40:43], s45 offen lds
s_add_u32 s45, s45, s31
s_add_u32 m0, m0, s58
K1_WS1:
s_nop 0
s_cbranch_vccz K1_WS2
buffer_load_dwordx4 v12, s[40:43], s45 offen lds
s_add_u32 s45, s45, s31
s_add_u32 m0, m0, s58
K1_WS2:
s_nop 0
s_cbranch_vccz K1_WS3
buffer_load_dwordx4 v12, s[40:43], s45 offen lds
s_add_u32 s45, s45, s31
s_add_u32 m0, m0, s58
K1_WS3:
s_nop 0
s_cbranch_vccz K1_WS4
buffer_load_dwordx4 v12, s[40:43], s45 offen lds
s_add_u32 s45, s45, s31
s_add_u32 m0, m0, s58
K1_WS4:
s_nop 0
s_cbranch_vccz K1_WS5
buffer_load_dwordx4 v12, s[40:43], s45 offen lds
s_add_u32 s45, s45, s31
s_add_u32 m0, m0, s58
K1_WS5:
s_nop 0
K1_NW2:
ds_read_b128 v[68:71], v66 offset:0
ds_read_b128 v[72:75], v66 offset:16
ds_read_b128 v[76:79], v66 offset:32
ds_read_b128 v[80:83], v66 offset:48
ds_read_b128 v[84:87], v66 offset:64
ds_read_b128 v[88:91], v66 offset:80
ds_read_b128 v[92:95], v66 offset:96
ds_read_b128 v[96:99], v66 offset:112
s_waitcnt lgkmcnt(0)
v_add_f32 v64, v68, v70
v_add_f32 v65, v69, v71
v_add_f32 v64, v64, v72
v_add_f32 v65, v65, v73
v_add_f32 v64, v64, v74
v_add_f32 v65, v65, v75
v_add_f32 v64, v64, v76
v_add_f32 v65, v65, v77
v_add_f32 v64, v64, v78
v_add_f32 v65, v65, v79
v_add_f32 v64, v64, v80
v_add_f32 v65, v65, v81
v_add_f32 v64, v64, v82
v_add_f32 v65, v65, v83
v_add_f32 v64, v64, v84
v_add_f32 v65, v65, v85
v_add_f32 v64, v64, v86
v_add_f32 v65, v65, v87
v_add_f32 v64, v64, v88
v_add_f32 v65, v65, v89
v_add_f32 v64, v64, v90
v_add_f32 v65, v65, v91
v_add_f32 v64, v64, v92
v_add_f32 v65, v65, v93
v_add_f32 v64, v64, v94
v_add_f32 v65, v65, v95
v_add_f32 v64, v64, v96
v_add_f32 v65, v65, v97
v_add_f32 v64, v64, v98
v_add_f32 v65, v65, v99
v_mul_f32 v64, 0x3d800000, v64
v_mov_b32 v66, 0
v_sub_f32 v67, v68, v64
v_fmac_f32 v66, v67, v67
v_sub_f32 v67, v70, v64
v_fmac_f32 v66, v67, v67
v_sub_f32 v67, v72, v64
v_fmac_f32 v66, v67, v67
v_sub_f32 v67, v74, v64
v_fmac_f32 v66, v67, v67
v_sub_f32 v67, v76, v64
v_fmac_f32 v66, v67, v67
v_sub_f32 v67, v78, v64
v_fmac_f32 v66, v67, v67
v_sub_f32 v67, v80, v64
v_fmac_f32 v66, v67, v67
v_sub_f32 v67, v82, v64
v_fmac_f32 v66, v67, v67
v_sub_f32 v67, v84, v64
v_fmac_f32 v66, v67, v67
v_sub_f32 v67, v86, v64
v_fmac_f32 v66, v67, v67
v_sub_f32 v67, v88, v64
v_fmac_f32 v66, v67, v67
v_sub_f32 v67, v90, v64
v_fmac_f32 v66, v67, v67
v_sub_f32 v67, v92, v64
v_fmac_f32 v66, v67, v67
v_sub_f32 v67, v94, v64
v_fmac_f32 v66, v67, v67
v_sub_f32 v67, v96, v64
v_fmac_f32 v66, v67, v67
v_sub_f32 v67, v98, v64
v_fmac_f32 v66, v67, v67
v_mul_f32 v66, 0x42000000, v66
v_add_f32 v65, v65, v66
v_mul_f32 v65, 0x3b000000, v65
v_cvt_pk_bf16_f32 v64, v64, v64
v_and_b32 v64, 0xffff0000, v64
v_cvt_pk_bf16_f32 v65, v65, v65
v_and_b32 v65, 0xffff0000, v65
v_add_f32 v65, 0x3727c5ac, v65
v_cvt_pk_bf16_f32 v65, v65, v65
v_and_b32 v65, 0xffff0000, v65
v_sqrt_f32 v65, v65
s_nop 0
v_cvt_pk_bf16_f32 v65, v65, v65
v_and_b32 v65, 0xffff0000, v65
v_rcp_f32 v65, v65
s_cbranch_vccz K1_WS6
buffer_load_dwordx4 v12, s[40:43], s45 offen lds
s_add_u32 s45, s45, s31
s_add_u32 m0, m0, s58
K1_WS6:
s_nop 0
v_sub_f32 v32, v32, v64
v_sub_f32 v33, v33, v64
v_cvt_pk_bf16_f32 v67, v32, v33
v_lshlrev_b32 v32, 16, v67
v_and_b32 v33, 0xffff0000, v67
v_mul_f32 v32, v32, v65
v_mul_f32 v33, v33, v65
v_cvt_pk_bf16_f32 v16, v32, v33
s_cbranch_vccz K1_WS7
buffer_load_dwordx4 v12, s[40:43], s45 offen lds
s_add_u32 s45, s45, s31
s_add_u32 m0, m0, s58
K1_WS7:
s_nop 0
v_sub_f32 v34, v34, v64
v_sub_f32 v35, v35, v64
v_cvt_pk_bf16_f32 v67, v34, v35
v_lshlrev_b32 v34, 16, v67
v_and_b32 v35, 0xffff0000, v67
v_mul_f32 v34, v34, v65
v_mul_f32 v35, v35, v65
v_cvt_pk_bf16_f32 v17, v34, v35
s_cbranch_vccz K1_WS8
buffer_load_dwordx4 v12, s[40:43], s45 offen lds
s_add_u32 s45, s45, s31
s_add_u32 m0, m0, s58
K1_WS8:
s_nop 0
v_sub_f32 v36, v36, v64
v_sub_f32 v37, v37, v64
v_cvt_pk_bf16_f32 v67, v36, v37
v_lshlrev_b32 v36, 16, v67
v_and_b32 v37, 0xffff0000, v67
v_mul_f32 v36, v36, v65
v_mul_f32 v37, v37, v65
v_cvt_pk_bf16_f32 v18, v36, v37
s_cbranch_vccz K1_WS9
buffer_load_dwordx4 v12, s[40:43], s45 offen lds
s_add_u32 s45, s45, s31
s_add_u32 m0, m0, s58
K1_WS9:
s_nop 0
v_sub_f32 v38, v38, v64
v_sub_f32 v39, v39, v64
v_cvt_pk_bf16_f32 v67, v38, v39
v_lshlrev_b32 v38, 16, v67
v_and_b32 v39, 0xffff0000, v67
v_mul_f32 v38, v38, v65
v_mul_f32 v39, v39, v65
v_cvt_pk_bf16_f32 v19, v38, v39
s_cbranch_vccz K1_WS10
buffer_load_dwordx4 v12, s[40:43], s45 offen lds
s_add_u32 s45, s45, s31
s_add_u32 m0, m0, s58
K1_WS10:
s_nop 0
v_sub_f32 v40, v40, v64
v_sub_f32 v41, v41, v64
v_cvt_pk_bf16_f32 v67, v40, v41
v_lshlrev_b32 v40, 16, v67
v_and_b32 v41, 0xffff0000, v67
v_mul_f32 v40, v40, v65
v_mul_f32 v41, v41, v65
v_cvt_pk_bf16_f32 v20, v40, v41
s_cbranch_vccz K1_WS11
buffer_load_dwordx4 v12, s[40:43], s45 offen lds
s_add_u32 s45, s45, s31
s_add_u32 m0, m0, s58
K1_WS11:
s_nop 0
v_sub_f32 v42, v42, v64
v_sub_f32 v43, v43, v64
v_cvt_pk_bf16_f32 v67, v42, v43
v_lshlrev_b32 v42, 16, v67
v_and_b32 v43, 0xffff0000, v67
v_mul_f32 v42, v42, v65
v_mul_f32 v43, v43, v65
v_cvt_pk_bf16_f32 v21, v42, v43
s_cbranch_vccz K1_WS12
buffer_load_dwordx4 v12, s[40:43], s45 offen lds
s_add_u32 s45, s45, s31
s_add_u32 m0, m0, s58
K1_WS12:
s_nop 0
v_sub_f32 v44, v44, v64
v_sub_f32 v45, v45, v64
v_cvt_pk_bf16_f32 v67, v44, v45
v_lshlrev_b32 v44, 16, v67
v_and_b32 v45, 0xffff0000, v67
v_mul_f32 v44, v44, v65
v_mul_f32 v45, v45, v65
v_cvt_pk_bf16_f32 v22, v44, v45
s_cbranch_vccz K1_WS13
buffer_load_dwordx4 v12, s[40:43], s45 offen lds
s_add_u32 s45, s45, s31
s_add_u32 m0, m0, s58
K1_WS13:
s_nop 0
v_sub_f32 v46, v46, v64
v_sub_f32 v47, v47, v64
v_cvt_pk_bf16_f32 v67, v46, v47
v_lshlrev_b32 v46, 16, v67
v_and_b32 v47, 0xffff0000, v67
v_mul_f32 v46, v46, v65
v_mul_f32 v47, v47, v65
v_cvt_pk_bf16_f32 v23, v46, v47
s_cbranch_vccz K1_WS14
buffer_load_dwordx4 v12, s[40:43], s45 offen lds
s_add_u32 s45, s45, s31
s_add_u32 m0, m0, s58
K1_WS14:
s_nop 0
v_sub_f32 v48, v48, v64
v_sub_f32 v49, v49, v64
v_cvt_pk_bf16_f32 v67, v48, v49
v_lshlrev_b32 v48, 16, v67
v_and_b32 v49, 0xffff0000, v67
v_mul_f32 v48, v48, v65
v_mul_f32 v49, v49, v65
v_cvt_pk_bf16_f32 v24, v48, v49
s_cbranch_vccz K1_WS15
buffer_load_dwordx4 v12, s[40:43], s45 offen lds
s_add_u32 s45, s45, s31
s_add_u32 m0, m0, s58
K1_WS15:
s_nop 0
v_sub_f32 v50, v50, v64
v_sub_f32 v51, v51, v64
v_cvt_pk_bf16_f32 v67, v50, v51
v_lshlrev_b32 v50, 16, v67
v_and_b32 v51, 0xffff0000, v67
v_mul_f32 v50, v50, v65
v_mul_f32 v51, v51, v65
v_cvt_pk_bf16_f32 v25, v50, v51
s_cbranch_vccz K1_WS16
buffer_load_dwordx4 v12, s[40:43], s45 offen lds
s_add_u32 s45, s45, s31
s_add_u32 m0, m0, s58
K1_WS16:
s_nop 0
v_sub_f32 v52, v52, v64
v_sub_f32 v53, v53, v64
v_cvt_pk_bf16_f32 v67, v52, v53
v_lshlrev_b32 v52, 16, v67
v_and_b32 v53, 0xffff0000, v67
v_mul_f32 v52, v52, v65
v_mul_f32 v53, v53, v65
v_cvt_pk_bf16_f32 v26, v52, v53
v_sub_f32 v54, v54, v64
v_sub_f32 v55, v55, v64
v_cvt_pk_bf16_f32 v67, v54, v55
v_lshlrev_b32 v54, 16, v67
v_and_b32 v55, 0xffff0000, v67
v_mul_f32 v54, v54, v65
v_mul_f32 v55, v55, v65
v_cvt_pk_bf16_f32 v27, v54, v55
v_sub_f32 v56, v56, v64
v_sub_f32 v57, v57, v64
v_cvt_pk_bf16_f32 v67, v56, v57
v_lshlrev_b32 v56, 16, v67
v_and_b32 v57, 0xffff0000, v67
v_mul_f32 v56, v56, v65
v_mul_f32 v57, v57, v65
v_cvt_pk_bf16_f32 v28, v56, v57
v_sub_f32 v58, v58, v64
v_sub_f32 v59, v59, v64
v_cvt_pk_bf16_f32 v67, v58, v59
v_lshlrev_b32 v58, 16, v67
v_and_b32 v59, 0xffff0000, v67
v_mul_f32 v58, v58, v65
v_mul_f32 v59, v59, v65
v_cvt_pk_bf16_f32 v29, v58, v59
v_sub_f32 v60, v60, v64
v_sub_f32 v61, v61, v64
v_cvt_pk_bf16_f32 v67, v60, v61
v_lshlrev_b32 v60, 16, v67
v_and_b32 v61, 0xffff0000, v67
v_mul_f32 v60, v60, v65
v_mul_f32 v61, v61, v65
v_cvt_pk_bf16_f32 v30, v60, v61
v_sub_f32 v62, v62, v64
v_sub_f32 v63, v63, v64
v_cvt_pk_bf16_f32 v67, v62, v63
v_lshlrev_b32 v62, 16, v67
v_and_b32 v63, 0xffff0000, v67
v_mul_f32 v62, v62, v65
v_mul_f32 v63, v63, v65
v_cvt_pk_bf16_f32 v31, v62, v63
s_lshl_b32 s54, s24, 12
v_add_u32 v67, s54, v9
ds_write_b128 v67, v[16:19] offset:0
ds_write_b128 v67, v[20:23] offset:1024
ds_write_b128 v67, v[24:27] offset:2048
ds_write_b128 v67, v[28:31] offset:3072
s_cmp_eq_u32 s59, 1
s_cbranch_scc1 K1_MM
s_waitcnt lgkmcnt(0)
s_barrier
s_waitcnt vmcnt(0)
s_lshr_b32 s60, s24, 1
s_cmp_lg_u32 s60, s26
s_cbranch_scc1 K1_NOXN0
s_lshl_b32 s60, s25, 15
s_lshl_b32 s61, s24, 12
s_add_u32 s60, s60, s61
buffer_store_dwordx4 v[16:19], v9, s[36:39], s60 offen offset:0 sc1
buffer_store_dwordx4 v[20:23], v9, s[36:39], s60 offen offset:1024 sc1
buffer_store_dwordx4 v[24:27], v9, s[36:39], s60 offen offset:2048 sc1
buffer_store_dwordx4 v[28:31], v9, s[36:39], s60 offen offset:3072 sc1
K1_NOXN0:
s_cmp_eq_u32 s59, 0
s_cbranch_scc1 K1_BE
ds_read_b64_tr_b16 v[32:33], v13 offset:0
ds_read_b64_tr_b16 v[34:35], v14 offset:0
ds_read_b64_tr_b16 v[36:37], v13 offset:1024
ds_read_b64_tr_b16 v[38:39], v14 offset:1024
ds_read_b64_tr_b16 v[40:41], v13 offset:2048
ds_read_b64_tr_b16 v[42:43], v14 offset:2048
ds_read_b64_tr_b16 v[44:45], v13 offset:3072
ds_read_b64_tr_b16 v[46:47], v14 offset:3072
ds_read_b64_tr_b16 v[48:49], v13 offset:4096
ds_read_b64_tr_b16 v[50:51], v14 offset:4096
ds_read_b64_tr_b16 v[52:53], v13 offset:5120
ds_read_b64_tr_b16 v[54:55], v14 offset:5120
ds_read_b64_tr_b16 v[56:57], v13 offset:6144
ds_read_b64_tr_b16 v[58:59], v14 offset:6144
ds_read_b64_tr_b16 v[60:61], v13 offset:7168
ds_read_b64_tr_b16 v[62:63], v14 offset:7168
s_waitcnt lgkmcnt(14)
buffer_store_dwordx4 v[32:35], v9, s[36:39], s50 offen sc1
s_add_u32 s50, s50, s52
s_waitcnt lgkmcnt(12)
buffer_store_dwordx4 v[36:39], v9, s[36:39], s50 offen sc1
s_add_u32 s50, s50, s52
s_waitcnt lgkmcnt(10)
buffer_store_dwordx4 v[40:43], v9, s[36:39], s50 offen sc1
s_add_u32 s50, s50, s52
s_waitcnt lgkmcnt(8)
buffer_store_dwordx4 v[44:47], v9, s[36:39], s50 offen sc1
s_mul_i32 s49, s52, 3
s_sub_u32 s50, s50, s49
s_add_u32 s50, s50, s51
s_waitcnt lgkmcnt(6)
buffer_store_dwordx4 v[48:51], v9, s[36:39], s50 offen sc1
s_add_u32 s50, s50, s52
s_waitcnt lgkmcnt(4)
buffer_store_dwordx4 v[52:55], v9, s[36:39], s50 offen sc1
s_add_u32 s50, s50, s52
s_waitcnt lgkmcnt(2)
buffer_store_dwordx4 v[56:59], v9, s[36:39], s50 offen sc1
s_add_u32 s50, s50, s52
s_waitcnt lgkmcnt(0)
buffer_store_dwordx4 v[60:63], v9, s[36:39], s50 offen sc1
s_add_u32 s50, s50, s52
K1_BE:
s_barrier
s_branch K1_END
K1_MM:
s_waitcnt lgkmcnt(0)
s_barrier
v_mov_b32 v100, 0
v_mov_b32 v101, 0
v_mov_b32 v102, 0
v_mov_b32 v103, 0
v_mov_b32 v104, 0
v_mov_b32 v105, 0
v_mov_b32 v106, 0
v_mov_b32 v107, 0
v_mov_b32 v108, 0
v_mov_b32 v109, 0
v_mov_b32 v110, 0
v_mov_b32 v111, 0
v_mov_b32 v112, 0
v_mov_b32 v113, 0
v_mov_b32 v114, 0
v_mov_b32 v115, 0
s_cmp_eq_u32 s24, 4
s_cselect_b32 s56, s26, 0
s_cmp_eq_u32 s56, 1
s_cbranch_scc1 K1_V
ds_read_b128 v[32:35], v9 offset:0
ds_read_b128 v[36:39], v9 offset:1024
ds_read_b128 v[40:43], v9 offset:2048
ds_read_b128 v[44:47], v9 offset:3072
ds_read_b128 v[48:51], v9 offset:4096
ds_read_b128 v[52:55], v9 offset:5120
ds_read_b128 v[56:59], v9 offset:6144
ds_read_b128 v[60:63], v9 offset:7168
ds_read_b128 v[64:67], v9 offset:8192
ds_read_b128 v[68:71], v9 offset:9216
ds_read_b128 v[72:75], v9 offset:10240
ds_read_b128 v[76:79], v9 offset:11264
ds_read_b128 v[80:83], v9 offset:12288
ds_read_b128 v[84:87], v9 offset:13312
ds_read_b128 v[88:91], v9 offset:14336
ds_read_b128 v[92:95], v9 offset:15360
s_waitcnt lgkmcnt(15)
v_mfma_f32_32x32x16_bf16 v[100:115], v[128:131], v[32:35], v[100:115]
s_waitcnt lgkmcnt(14)
v_mfma_f32_32x32x16_bf16 v[100:115], v[132:135], v[36:39], v[100:115]
s_waitcnt lgkmcnt(13)
v_mfma_f32_32x32x16_bf16 v[100:115], v[136:139], v[40:43], v[100:115]
s_waitcnt lgkmcnt(12)
v_mfma_f32_32x32x16_bf16 v[100:115], v[140:143], v[44:47], v[100:115]
s_waitcnt lgkmcnt(11)
v_mfma_f32_32x32x16_bf16 v[100:115], v[144:147], v[48:51], v[100:115]
s_waitcnt lgkmcnt(10)
v_mfma_f32_32x32x16_bf16 v[100:115], v[148:151], v[52:55], v[100:115]
s_waitcnt lgkmcnt(9)
v_mfma_f32_32x32x16_bf16 v[100:115], v[152:155], v[56:59], v[100:115]
s_waitcnt lgkmcnt(8)
v_mfma_f32_32x32x16_bf16 v[100:115], v[156:159], v[60:63], v[100:115]
s_waitcnt lgkmcnt(7)
v_mfma_f32_32x32x16_bf16 v[100:115], v[160:163], v[64:67], v[100:115]
s_waitcnt lgkmcnt(6)
v_mfma_f32_32x32x16_bf16 v[100:115], v[164:167], v[68:71], v[100:115]
s_waitcnt lgkmcnt(5)
v_mfma_f32_32x32x16_bf16 v[100:115], v[168:171], v[72:75], v[100:115]
s_waitcnt lgkmcnt(4)
v_mfma_f32_32x32x16_bf16 v[100:115], v[172:175], v[76:79], v[100:115]
s_waitcnt lgkmcnt(3)
v_mfma_f32_32x32x16_bf16 v[100:115], v[176:179], v[80:83], v[100:115]
s_waitcnt lgkmcnt(2)
v_mfma_f32_32x32x16_bf16 v[100:115], v[180:183], v[84:87], v[100:115]
s_waitcnt lgkmcnt(1)
v_mfma_f32_32x32x16_bf16 v[100:115], v[184:187], v[88:91], v[100:115]
s_waitcnt lgkmcnt(0)
v_mfma_f32_32x32x16_bf16 v[100:115], v[188:191], v[92:95], v[100:115]
s_waitcnt vmcnt(0)
s_barrier
s_cmp_eq_u32 s24, 4
s_cbranch_scc1 K1_TA1
ds_read_b64_tr_b16 v[192:193], v13 offset:0
ds_read_b64_tr_b16 v[194:195], v13 offset:512
ds_read_b64_tr_b16 v[196:197], v13 offset:2048
ds_read_b64_tr_b16 v[198:199], v13 offset:2560
ds_read_b64_tr_b16 v[200:201], v13 offset:4096
ds_read_b64_tr_b16 v[202:203], v13 offset:4608
ds_read_b64_tr_b16 v[204:205], v13 offset:6144
ds_read_b64_tr_b16 v[206:207], v13 offset:6656
ds_read_b64_tr_b16 v[208:209], v13 offset:8192
ds_read_b64_tr_b16 v[210:211], v13 offset:8704
ds_read_b64_tr_b16 v[212:213], v13 offset:10240
ds_read_b64_tr_b16 v[214:215], v13 offset:10752
ds_read_b64_tr_b16 v[216:217], v13 offset:12288
ds_read_b64_tr_b16 v[218:219], v13 offset:12800
ds_read_b64_tr_b16 v[220:221], v13 offset:14336
ds_read_b64_tr_b16 v[222:223], v13 offset:14848
ds_read_b64_tr_b16 v[224:225], v13 offset:16384
ds_read_b64_tr_b16 v[226:227], v13 offset:16896
ds_read_b64_tr_b16 v[228:229], v13 offset:18432
ds_read_b64_tr_b16 v[230:231], v13 offset:18944
ds_read_b64_tr_b16 v[232:233], v13 offset:20480
ds_read_b64_tr_b16 v[234:235], v13 offset:20992
ds_read_b64_tr_b16 v[236:237], v13 offset:22528
ds_read_b64_tr_b16 v[238:239], v13 offset:23040
ds_read_b64_tr_b16 v[240:241], v13 offset:24576
ds_read_b64_tr_b16 v[242:243], v13 offset:25088
ds_read_b64_tr_b16 v[244:245], v13 offset:26624
ds_read_b64_tr_b16 v[246:247], v13 offset:27136
ds_read_b64_tr_b16 v[248:249], v13 offset:28672
ds_read_b64_tr_b16 v[250:251], v13 offset:29184
ds_read_b64_tr_b16 v[252:253], v13 offset:30720
ds_read_b64_tr_b16 v[254:255], v13 offset:31232
s_branch K1_TB1
K1_TA1:
ds_read_b64_tr_b16 v[192:193], v13 offset:0
ds_read_b64_tr_b16 v[194:195], v13 offset:256
ds_read_b64_tr_b16 v[196:197], v13 offset:1024
ds_read_b64_tr_b16 v[198:199], v13 offset:1280
ds_read_b64_tr_b16 v[200:201], v13 offset:2048
ds_read_b64_tr_b16 v[202:203], v13 offset:2304
ds_read_b64_tr_b16 v[204:205], v13 offset:3072
ds_read_b64_tr_b16 v[206:207], v13 offset:3328
ds_read_b64_tr_b16 v[208:209], v13 offset:4096
ds_read_b64_tr_b16 v[210:211], v13 offset:4352
ds_read_b64_tr_b16 v[212:213], v13 offset:5120
ds_read_b64_tr_b16 v[214:215], v13 offset:5376
ds_read_b64_tr_b16 v[216:217], v13 offset:6144
ds_read_b64_tr_b16 v[218:219], v13 offset:6400
ds_read_b64_tr_b16 v[220:221], v13 offset:7168
ds_read_b64_tr_b16 v[222:223], v13 offset:7424
ds_read_b64_tr_b16 v[224:225], v13 offset:8192
ds_read_b64_tr_b16 v[226:227], v13 offset:8448
ds_read_b64_tr_b16 v[228:229], v13 offset:9216
ds_read_b64_tr_b16 v[230:231], v13 offset:9472
ds_read_b64_tr_b16 v[232:233], v13 offset:10240
ds_read_b64_tr_b16 v[234:235], v13 offset:10496
ds_read_b64_tr_b16 v[236:237], v13 offset:11264
ds_read_b64_tr_b16 v[238:239], v13 offset:11520
ds_read_b64_tr_b16 v[240:241], v13 offset:12288
ds_read_b64_tr_b16 v[242:243], v13 offset:12544
ds_read_b64_tr_b16 v[244:245], v13 offset:13312
ds_read_b64_tr_b16 v[246:247], v13 offset:13568
ds_read_b64_tr_b16 v[248:249], v13 offset:14336
ds_read_b64_tr_b16 v[250:251], v13 offset:14592
ds_read_b64_tr_b16 v[252:253], v13 offset:15360
ds_read_b64_tr_b16 v[254:255], v13 offset:15616
K1_TB1:
s_waitcnt lgkmcnt(0)
s_lshr_b32 s60, s24, 1
s_cmp_lg_u32 s60, s26
s_cbranch_scc1 K1_NOXN1
s_lshl_b32 s60, s25, 15
s_lshl_b32 s61, s24, 12
s_add_u32 s60, s60, s61
buffer_store_dwordx4 v[16:19], v9, s[36:39], s60 offen offset:0 sc1
buffer_store_dwordx4 v[20:23], v9, s[36:39], s60 offen offset:1024 sc1
buffer_store_dwordx4 v[24:27], v9, s[36:39], s60 offen offset:2048 sc1
buffer_store_dwordx4 v[28:31], v9, s[36:39], s60 offen offset:3072 sc1
K1_NOXN1:
ds_read_b128 v[32:35], v9 offset:16384
ds_read_b128 v[36:39], v9 offset:17408
ds_read_b128 v[40:43], v9 offset:18432
ds_read_b128 v[44:47], v9 offset:19456
ds_read_b128 v[48:51], v9 offset:20480
ds_read_b128 v[52:55], v9 offset:21504
ds_read_b128 v[56:59], v9 offset:22528
ds_read_b128 v[60:63], v9 offset:23552
ds_read_b128 v[64:67], v9 offset:24576
ds_read_b128 v[68:71], v9 offset:25600
ds_read_b128 v[72:75], v9 offset:26624
ds_read_b128 v[76:79], v9 offset:27648
ds_read_b128 v[80:83], v9 offset:28672
ds_read_b128 v[84:87], v9 offset:29696
ds_read_b128 v[88:91], v9 offset:30720
ds_read_b128 v[92:95], v9 offset:31744
s_waitcnt lgkmcnt(15)
v_mfma_f32_32x32x16_bf16 v[100:115], v[192:195], v[32:35], v[100:115]
s_waitcnt lgkmcnt(14)
v_mfma_f32_32x32x16_bf16 v[100:115], v[196:199], v[36:39], v[100:115]
s_waitcnt lgkmcnt(13)
v_mfma_f32_32x32x16_bf16 v[100:115], v[200:203], v[40:43], v[100:115]
s_waitcnt lgkmcnt(12)
v_mfma_f32_32x32x16_bf16 v[100:115], v[204:207], v[44:47], v[100:115]
s_waitcnt lgkmcnt(11)
v_mfma_f32_32x32x16_bf16 v[100:115], v[208:211], v[48:51], v[100:115]
s_waitcnt lgkmcnt(10)
v_mfma_f32_32x32x16_bf16 v[100:115], v[212:215], v[52:55], v[100:115]
s_waitcnt lgkmcnt(9)
v_mfma_f32_32x32x16_bf16 v[100:115], v[216:219], v[56:59], v[100:115]
s_waitcnt lgkmcnt(8)
v_mfma_f32_32x32x16_bf16 v[100:115], v[220:223], v[60:63], v[100:115]
s_waitcnt lgkmcnt(7)
v_mfma_f32_32x32x16_bf16 v[100:115], v[224:227], v[64:67], v[100:115]
s_waitcnt lgkmcnt(6)
v_mfma_f32_32x32x16_bf16 v[100:115], v[228:231], v[68:71], v[100:115]
s_waitcnt lgkmcnt(5)
v_mfma_f32_32x32x16_bf16 v[100:115], v[232:235], v[72:75], v[100:115]
s_waitcnt lgkmcnt(4)
v_mfma_f32_32x32x16_bf16 v[100:115], v[236:239], v[76:79], v[100:115]
s_waitcnt lgkmcnt(3)
v_mfma_f32_32x32x16_bf16 v[100:115], v[240:243], v[80:83], v[100:115]
s_waitcnt lgkmcnt(2)
v_mfma_f32_32x32x16_bf16 v[100:115], v[244:247], v[84:87], v[100:115]
s_waitcnt lgkmcnt(1)
v_mfma_f32_32x32x16_bf16 v[100:115], v[248:251], v[88:91], v[100:115]
s_waitcnt lgkmcnt(0)
v_mfma_f32_32x32x16_bf16 v[100:115], v[252:255], v[92:95], v[100:115]
s_nop 15
s_cmp_eq_u32 s24, 4
s_cbranch_scc1 K1_K
v_mul_f32 v100, 0x3eb8aa3b, v100
v_mul_f32 v101, 0x3eb8aa3b, v101
v_mul_f32 v102, 0x3eb8aa3b, v102
v_mul_f32 v103, 0x3eb8aa3b, v103
v_mul_f32 v104, 0x3eb8aa3b, v104
v_mul_f32 v105, 0x3eb8aa3b, v105
v_mul_f32 v106, 0x3eb8aa3b, v106
v_mul_f32 v107, 0x3eb8aa3b, v107
v_mul_f32 v108, 0x3eb8aa3b, v108
v_mul_f32 v109, 0x3eb8aa3b, v109
v_mul_f32 v110, 0x3eb8aa3b, v110
v_mul_f32 v111, 0x3eb8aa3b, v111
v_mul_f32 v112, 0x3eb8aa3b, v112
v_mul_f32 v113, 0x3eb8aa3b, v113
v_mul_f32 v114, 0x3eb8aa3b, v114
v_mul_f32 v115, 0x3eb8aa3b, v115
v_cvt_pk_bf16_f32 v32, v100, v101
v_cvt_pk_bf16_f32 v33, v102, v103
v_cvt_pk_bf16_f32 v34, v104, v105
v_cvt_pk_bf16_f32 v35, v106, v107
v_cvt_pk_bf16_f32 v36, v108, v109
v_cvt_pk_bf16_f32 v37, v110, v111
v_cvt_pk_bf16_f32 v38, v112, v113
v_cvt_pk_bf16_f32 v39, v114, v115
s_lshl_b32 s55, s25, 15
s_lshl_b32 s54, s29, 11
s_add_u32 s55, s55, s54
s_add_u32 s55, s55, 2097152
buffer_store_dwordx4 v[32:35], v9, s[36:39], s55 offen sc1
buffer_store_dwordx4 v[36:39], v9, s[36:39], s55 offen offset:1024 sc1
s_branch K1_END
K1_K:
v_cvt_pk_bf16_f32 v32, v100, v101
v_cvt_pk_bf16_f32 v33, v102, v103
v_cvt_pk_bf16_f32 v34, v104, v105
v_cvt_pk_bf16_f32 v35, v106, v107
s_lshl_b32 s55, s25, 10
s_add_u32 s55, s55, 4194304
buffer_store_dwordx4 v[32:35], v9, s[36:39], s55 offen sc1
v_mov_b32 v40, 0
v_lshlrev_b32 v41, 16, v32
v_and_b32 v42, 0xffff0000, v32
v_fmac_f32 v40, v41, v41
v_fmac_f32 v40, v42, v42
v_lshlrev_b32 v41, 16, v33
v_and_b32 v42, 0xffff0000, v33
v_fmac_f32 v40, v41, v41
v_fmac_f32 v40, v42, v42
v_lshlrev_b32 v41, 16, v34
v_and_b32 v42, 0xffff0000, v34
v_fmac_f32 v40, v41, v41
v_fmac_f32 v40, v42, v42
v_lshlrev_b32 v41, 16, v35
v_and_b32 v42, 0xffff0000, v35
v_fmac_f32 v40, v41, v41
v_fmac_f32 v40, v42, v42
v_mov_b32 v41, v40
s_nop 1
v_permlane32_swap_b32 v40, v41
s_nop 1
v_add_f32 v40, v40, v41
ds_swizzle_b32 v41, v40 offset:0x41f
s_waitcnt lgkmcnt(0)
v_max_f32 v40, v40, v41
ds_swizzle_b32 v41, v40 offset:0x81f
s_waitcnt lgkmcnt(0)
v_max_f32 v40, v40, v41
ds_swizzle_b32 v41, v40 offset:0x101f
s_waitcnt lgkmcnt(0)
v_max_f32 v40, v40, v41
ds_swizzle_b32 v41, v40 offset:0x201f
s_waitcnt lgkmcnt(0)
v_max_f32 v40, v40, v41
ds_swizzle_b32 v41, v40 offset:0x401f
s_waitcnt lgkmcnt(0)
v_max_f32 v40, v40, v41
s_lshl_b32 s55, s25, 2
s_add_u32 s55, s55, 4325376
v_mov_b32 v41, 0
s_mov_b64 exec, 1
buffer_store_dword v40, v41, s[36:39], s55 offen sc1
s_mov_b64 exec, 15
s_lshl_b32 s55, s25, 8
s_add_u32 s55, s55, 4390912
v_lshlrev_b32 v42, 6, v0
v_mov_b32 v41, 0
buffer_store_dword v41, v42, s[36:39], s55 offen sc1
s_branch K1_END
K1_V:
ds_read_b128 v[32:35], v9 offset:0
ds_read_b128 v[36:39], v9 offset:1024
ds_read_b128 v[40:43], v9 offset:2048
ds_read_b128 v[44:47], v9 offset:3072
ds_read_b128 v[48:51], v9 offset:4096
ds_read_b128 v[52:55], v9 offset:5120
ds_read_b128 v[56:59], v9 offset:6144
ds_read_b128 v[60:63], v9 offset:7168
ds_read_b128 v[64:67], v9 offset:8192
ds_read_b128 v[68:71], v9 offset:9216
ds_read_b128 v[72:75], v9 offset:10240
ds_read_b128 v[76:79], v9 offset:11264
ds_read_b128 v[80:83], v9 offset:12288
ds_read_b128 v[84:87], v9 offset:13312
ds_read_b128 v[88:91], v9 offset:14336
ds_read_b128 v[92:95], v9 offset:15360
s_waitcnt lgkmcnt(15)
v_mfma_f32_32x32x16_bf16 v[100:115], v[32:35], v[128:131], v[100:115]
s_waitcnt lgkmcnt(14)
v_mfma_f32_32x32x16_bf16 v[100:115], v[36:39], v[132:135], v[100:115]
s_waitcnt lgkmcnt(13)
v_mfma_f32_32x32x16_bf16 v[100:115], v[40:43], v[136:139], v[100:115]
s_waitcnt lgkmcnt(12)
v_mfma_f32_32x32x16_bf16 v[100:115], v[44:47], v[140:143], v[100:115]
s_waitcnt lgkmcnt(11)
v_mfma_f32_32x32x16_bf16 v[100:115], v[48:51], v[144:147], v[100:115]
s_waitcnt lgkmcnt(10)
v_mfma_f32_32x32x16_bf16 v[100:115], v[52:55], v[148:151], v[100:115]
s_waitcnt lgkmcnt(9)
v_mfma_f32_32x32x16_bf16 v[100:115], v[56:59], v[152:155], v[100:115]
s_waitcnt lgkmcnt(8)
v_mfma_f32_32x32x16_bf16 v[100:115], v[60:63], v[156:159], v[100:115]
s_waitcnt lgkmcnt(7)
v_mfma_f32_32x32x16_bf16 v[100:115], v[64:67], v[160:163], v[100:115]
s_waitcnt lgkmcnt(6)
v_mfma_f32_32x32x16_bf16 v[100:115], v[68:71], v[164:167], v[100:115]
s_waitcnt lgkmcnt(5)
v_mfma_f32_32x32x16_bf16 v[100:115], v[72:75], v[168:171], v[100:115]
s_waitcnt lgkmcnt(4)
v_mfma_f32_32x32x16_bf16 v[100:115], v[76:79], v[172:175], v[100:115]
s_waitcnt lgkmcnt(3)
v_mfma_f32_32x32x16_bf16 v[100:115], v[80:83], v[176:179], v[100:115]
s_waitcnt lgkmcnt(2)
v_mfma_f32_32x32x16_bf16 v[100:115], v[84:87], v[180:183], v[100:115]
s_waitcnt lgkmcnt(1)
v_mfma_f32_32x32x16_bf16 v[100:115], v[88:91], v[184:187], v[100:115]
s_waitcnt lgkmcnt(0)
v_mfma_f32_32x32x16_bf16 v[100:115], v[92:95], v[188:191], v[100:115]
s_waitcnt vmcnt(0)
s_barrier
s_cmp_eq_u32 s24, 4
s_cbranch_scc1 K1_TA2
ds_read_b64_tr_b16 v[192:193], v13 offset:0
ds_read_b64_tr_b16 v[194:195], v13 offset:512
ds_read_b64_tr_b16 v[196:197], v13 offset:2048
ds_read_b64_tr_b16 v[198:199], v13 offset:2560
ds_read_b64_tr_b16 v[200:201], v13 offset:4096
ds_read_b64_tr_b16 v[202:203], v13 offset:4608
ds_read_b64_tr_b16 v[204:205], v13 offset:6144
ds_read_b64_tr_b16 v[206:207], v13 offset:6656
ds_read_b64_tr_b16 v[208:209], v13 offset:8192
ds_read_b64_tr_b16 v[210:211], v13 offset:8704
ds_read_b64_tr_b16 v[212:213], v13 offset:10240
ds_read_b64_tr_b16 v[214:215], v13 offset:10752
ds_read_b64_tr_b16 v[216:217], v13 offset:12288
ds_read_b64_tr_b16 v[218:219], v13 offset:12800
ds_read_b64_tr_b16 v[220:221], v13 offset:14336
ds_read_b64_tr_b16 v[222:223], v13 offset:14848
ds_read_b64_tr_b16 v[224:225], v13 offset:16384
ds_read_b64_tr_b16 v[226:227], v13 offset:16896
ds_read_b64_tr_b16 v[228:229], v13 offset:18432
ds_read_b64_tr_b16 v[230:231], v13 offset:18944
ds_read_b64_tr_b16 v[232:233], v13 offset:20480
ds_read_b64_tr_b16 v[234:235], v13 offset:20992
ds_read_b64_tr_b16 v[236:237], v13 offset:22528
ds_read_b64_tr_b16 v[238:239], v13 offset:23040
ds_read_b64_tr_b16 v[240:241], v13 offset:24576
ds_read_b64_tr_b16 v[242:243], v13 offset:25088
ds_read_b64_tr_b16 v[244:245], v13 offset:26624
ds_read_b64_tr_b16 v[246:247], v13 offset:27136
ds_read_b64_tr_b16 v[248:249], v13 offset:28672
ds_read_b64_tr_b16 v[250:251], v13 offset:29184
ds_read_b64_tr_b16 v[252:253], v13 offset:30720
ds_read_b64_tr_b16 v[254:255], v13 offset:31232
s_branch K1_TB2
K1_TA2:
ds_read_b64_tr_b16 v[192:193], v13 offset:0
ds_read_b64_tr_b16 v[194:195], v13 offset:256
ds_read_b64_tr_b16 v[196:197], v13 offset:1024
ds_read_b64_tr_b16 v[198:199], v13 offset:1280
ds_read_b64_tr_b16 v[200:201], v13 offset:2048
ds_read_b64_tr_b16 v[202:203], v13 offset:2304
ds_read_b64_tr_b16 v[204:205], v13 offset:3072
ds_read_b64_tr_b16 v[206:207], v13 offset:3328
ds_read_b64_tr_b16 v[208:209], v13 offset:4096
ds_read_b64_tr_b16 v[210:211], v13 offset:4352
ds_read_b64_tr_b16 v[212:213], v13 offset:5120
ds_read_b64_tr_b16 v[214:215], v13 offset:5376
ds_read_b64_tr_b16 v[216:217], v13 offset:6144
ds_read_b64_tr_b16 v[218:219], v13 offset:6400
ds_read_b64_tr_b16 v[220:221], v13 offset:7168
ds_read_b64_tr_b16 v[222:223], v13 offset:7424
ds_read_b64_tr_b16 v[224:225], v13 offset:8192
ds_read_b64_tr_b16 v[226:227], v13 offset:8448
ds_read_b64_tr_b16 v[228:229], v13 offset:9216
ds_read_b64_tr_b16 v[230:231], v13 offset:9472
ds_read_b64_tr_b16 v[232:233], v13 offset:10240
ds_read_b64_tr_b16 v[234:235], v13 offset:10496
ds_read_b64_tr_b16 v[236:237], v13 offset:11264
ds_read_b64_tr_b16 v[238:239], v13 offset:11520
ds_read_b64_tr_b16 v[240:241], v13 offset:12288
ds_read_b64_tr_b16 v[242:243], v13 offset:12544
ds_read_b64_tr_b16 v[244:245], v13 offset:13312
ds_read_b64_tr_b16 v[246:247], v13 offset:13568
ds_read_b64_tr_b16 v[248:249], v13 offset:14336
ds_read_b64_tr_b16 v[250:251], v13 offset:14592
ds_read_b64_tr_b16 v[252:253], v13 offset:15360
ds_read_b64_tr_b16 v[254:255], v13 offset:15616
K1_TB2:
s_waitcnt lgkmcnt(0)
ds_read_b128 v[32:35], v9 offset:16384
ds_read_b128 v[36:39], v9 offset:17408
ds_read_b128 v[40:43], v9 offset:18432
ds_read_b128 v[44:47], v9 offset:19456
ds_read_b128 v[48:51], v9 offset:20480
ds_read_b128 v[52:55], v9 offset:21504
ds_read_b128 v[56:59], v9 offset:22528
ds_read_b128 v[60:63], v9 offset:23552
ds_read_b128 v[64:67], v9 offset:24576
ds_read_b128 v[68:71], v9 offset:25600
ds_read_b128 v[72:75], v9 offset:26624
ds_read_b128 v[76:79], v9 offset:27648
ds_read_b128 v[80:83], v9 offset:28672
ds_read_b128 v[84:87], v9 offset:29696
ds_read_b128 v[88:91], v9 offset:30720
ds_read_b128 v[92:95], v9 offset:31744
s_waitcnt lgkmcnt(15)
v_mfma_f32_32x32x16_bf16 v[100:115], v[32:35], v[192:195], v[100:115]
s_waitcnt lgkmcnt(14)
v_mfma_f32_32x32x16_bf16 v[100:115], v[36:39], v[196:199], v[100:115]
s_waitcnt lgkmcnt(13)
v_mfma_f32_32x32x16_bf16 v[100:115], v[40:43], v[200:203], v[100:115]
s_waitcnt lgkmcnt(12)
v_mfma_f32_32x32x16_bf16 v[100:115], v[44:47], v[204:207], v[100:115]
s_waitcnt lgkmcnt(11)
v_mfma_f32_32x32x16_bf16 v[100:115], v[48:51], v[208:211], v[100:115]
s_waitcnt lgkmcnt(10)
v_mfma_f32_32x32x16_bf16 v[100:115], v[52:55], v[212:215], v[100:115]
s_waitcnt lgkmcnt(9)
v_mfma_f32_32x32x16_bf16 v[100:115], v[56:59], v[216:219], v[100:115]
s_waitcnt lgkmcnt(8)
v_mfma_f32_32x32x16_bf16 v[100:115], v[60:63], v[220:223], v[100:115]
s_waitcnt lgkmcnt(7)
v_mfma_f32_32x32x16_bf16 v[100:115], v[64:67], v[224:227], v[100:115]
s_waitcnt lgkmcnt(6)
v_mfma_f32_32x32x16_bf16 v[100:115], v[68:71], v[228:231], v[100:115]
s_waitcnt lgkmcnt(5)
v_mfma_f32_32x32x16_bf16 v[100:115], v[72:75], v[232:235], v[100:115]
s_waitcnt lgkmcnt(4)
v_mfma_f32_32x32x16_bf16 v[100:115], v[76:79], v[236:239], v[100:115]
s_waitcnt lgkmcnt(3)
v_mfma_f32_32x32x16_bf16 v[100:115], v[80:83], v[240:243], v[100:115]
s_waitcnt lgkmcnt(2)
v_mfma_f32_32x32x16_bf16 v[100:115], v[84:87], v[244:247], v[100:115]
s_waitcnt lgkmcnt(1)
v_mfma_f32_32x32x16_bf16 v[100:115], v[88:91], v[248:251], v[100:115]
s_waitcnt lgkmcnt(0)
v_mfma_f32_32x32x16_bf16 v[100:115], v[92:95], v[252:255], v[100:115]
s_nop 15
v_cvt_pk_bf16_f32 v32, v100, v101
v_cvt_pk_bf16_f32 v33, v102, v103
v_cvt_pk_bf16_f32 v34, v104, v105
v_cvt_pk_bf16_f32 v35, v106, v107
v_cvt_pk_bf16_f32 v36, v108, v109
v_cvt_pk_bf16_f32 v37, v110, v111
v_cvt_pk_bf16_f32 v38, v112, v113
v_cvt_pk_bf16_f32 v39, v114, v115
v_lshlrev_b32 v40, 4, v2
v_lshl_add_u32 v40, v3, 8, v40
s_lshl_b32 s55, s25, 10
s_add_u32 s55, s55, 4259840
s_mov_b32 exec_lo, 0xffff
s_mov_b32 exec_hi, 0xffff
buffer_store_dwordx4 v[32:35], v40, s[36:39], s55 offen sc1
buffer_store_dwordx4 v[36:39], v40, s[36:39], s55 offen offset:512 sc1
K1_END:
s_endpgm
.text
.globl main_kernel
.p2align 8
.type main_kernel,@function
main_kernel:
s_cmp_ge_u32 s2, 256
s_cbranch_scc1 K2_END
s_load_dwordx2 s[22:23], s[0:1], 88
s_load_dwordx2 s[4:5], s[0:1], 0
s_load_dwordx2 s[6:7], s[0:1], 72
v_lshrrev_b32 v1, 6, v0
v_and_b32 v0, 63, v0
s_nop 0
v_readfirstlane_b32 s24, v1
s_lshr_b32 s25, s2, 2
s_and_b32 s26, s2, 3
v_and_b32 v2, 31, v0
v_lshrrev_b32 v3, 5, v0
v_lshlrev_b32 v9, 4, v0
s_lshl_b32 s27, s25, 15
s_waitcnt lgkmcnt(0)
s_mov_b32 s36, s22
s_mov_b32 s37, s23
s_mov_b32 s38, 33554432
s_mov_b32 s39, 0x00020000
s_cmp_ge_u32 s24, 4
s_cbranch_scc1 K2_FFN
s_setprio 3
s_lshl_b32 s28, s26, 13
s_lshl_b32 s29, s24, 11
s_add_u32 s28, s28, s29
s_add_u32 s28, s28, s27
s_add_u32 s28, s28, 2097152
buffer_load_dwordx4 v[16:19], v9, s[36:39], s28 offen
buffer_load_dwordx4 v[20:23], v9, s[36:39], s28 offen offset:1024
v_lshlrev_b32 v4, 2, v0
s_mov_b32 s28, 4325376
buffer_load_dword v5, v4, s[36:39], s28 offen
s_lshl_b32 s29, s24, 10
s_mov_b32 m0, s29
s_add_u32 s28, s29, 4194304
s_nop 0
buffer_load_dwordx4 v9, s[36:39], s28 offen lds
s_add_u32 m0, m0, 65536
s_add_u32 s28, s28, 65536
s_nop 0
buffer_load_dwordx4 v9, s[36:39], s28 offen lds
s_sub_u32 m0, m0, 61440
s_sub_u32 s28, s28, 61440
s_nop 0
buffer_load_dwordx4 v9, s[36:39], s28 offen lds
s_add_u32 m0, m0, 65536
s_add_u32 s28, s28, 65536
s_nop 0
buffer_load_dwordx4 v9, s[36:39], s28 offen lds
s_sub_u32 m0, m0, 61440
s_sub_u32 s28, s28, 61440
s_nop 0
buffer_load_dwordx4 v9, s[36:39], s28 offen lds
s_add_u32 m0, m0, 65536
s_add_u32 s28, s28, 65536
s_nop 0
buffer_load_dwordx4 v9, s[36:39], s28 offen lds
s_sub_u32 m0, m0, 61440
s_sub_u32 s28, s28, 61440
s_nop 0
buffer_load_dwordx4 v9, s[36:39], s28 offen lds
s_add_u32 m0, m0, 65536
s_add_u32 s28, s28, 65536
s_nop 0
buffer_load_dwordx4 v9, s[36:39], s28 offen lds
s_sub_u32 m0, m0, 61440
s_sub_u32 s28, s28, 61440
v_and_b32 v8, 27, v0
v_cmp_eq_u32 vcc, 16, v8
v_mov_b32 v8, 0x3f803f80
v_cndmask_b32 v8, 0, v8, vcc
v_mov_b32 v160, v8
v_mov_b32 v161, v8
v_mov_b32 v162, v8
v_mov_b32 v163, v8
v_mov_b32 v164, v8
v_mov_b32 v165, v8
v_mov_b32 v166, v8
v_mov_b32 v167, v8
v_mov_b32 v168, v8
v_mov_b32 v169, v8
v_mov_b32 v170, v8
v_mov_b32 v171, v8
v_mov_b32 v172, v8
v_mov_b32 v173, v8
v_mov_b32 v174, v8
v_mov_b32 v175, v8
v_mov_b32 v176, v8
v_mov_b32 v177, v8
v_mov_b32 v178, v8
v_mov_b32 v179, v8
v_mov_b32 v180, v8
v_mov_b32 v181, v8
v_mov_b32 v182, v8
v_mov_b32 v183, v8
v_mov_b32 v184, v8
v_mov_b32 v185, v8
v_mov_b32 v186, v8
v_mov_b32 v187, v8
v_mov_b32 v188, v8
v_mov_b32 v189, v8
v_mov_b32 v190, v8
v_mov_b32 v191, v8
v_mov_b32 v112, 0
v_mov_b32 v113, 0
v_mov_b32 v114, 0
v_mov_b32 v115, 0
v_mov_b32 v116, 0
v_mov_b32 v117, 0
v_mov_b32 v118, 0
v_mov_b32 v119, 0
v_mov_b32 v120, 0
v_mov_b32 v121, 0
v_mov_b32 v122, 0
v_mov_b32 v123, 0
v_mov_b32 v124, 0
v_mov_b32 v125, 0
v_mov_b32 v126, 0
v_mov_b32 v127, 0
v_mov_b32 v128, 0
v_mov_b32 v129, 0
v_mov_b32 v130, 0
v_mov_b32 v131, 0
v_mov_b32 v132, 0
v_mov_b32 v133, 0
v_mov_b32 v134, 0
v_mov_b32 v135, 0
v_mov_b32 v136, 0
v_mov_b32 v137, 0
v_mov_b32 v138, 0
v_mov_b32 v139, 0
v_mov_b32 v140, 0
v_mov_b32 v141, 0
v_mov_b32 v142, 0
v_mov_b32 v143, 0
v_mov_b32 v104, 0
v_mov_b32 v105, 0
v_mov_b32 v106, 0
v_mov_b32 v107, 0
v_mov_b32 v108, 0
v_mov_b32 v109, 0
v_mov_b32 v110, 0
v_mov_b32 v111, 0
v_lshlrev_b32 v6, 4, v2
v_lshl_add_u32 v6, v3, 8, v6
v_add_u32 v6, 65536, v6
v_mov_b32 v7, v9
s_mov_b32 s30, 0xffff
s_mov_b32 s31, 0xffff
s_waitcnt vmcnt(8)
ds_swizzle_b32 v8, v5 offset:0x41f
s_waitcnt lgkmcnt(0)
v_max_f32 v5, v5, v8
ds_swizzle_b32 v8, v5 offset:0x81f
s_waitcnt lgkmcnt(0)
v_max_f32 v5, v5, v8
ds_swizzle_b32 v8, v5 offset:0x101f
s_waitcnt lgkmcnt(0)
v_max_f32 v5, v5, v8
ds_swizzle_b32 v8, v5 offset:0x201f
s_waitcnt lgkmcnt(0)
v_max_f32 v5, v5, v8
ds_swizzle_b32 v8, v5 offset:0x401f
s_waitcnt lgkmcnt(0)
v_max_f32 v5, v5, v8
v_mov_b32 v8, v5
s_nop 1
v_permlane32_swap_b32 v5, v8
s_nop 1
v_max_f32 v5, v5, v8
v_mov_b32 v10, 0
v_lshlrev_b32 v11, 16, v16
v_and_b32 v12, 0xffff0000, v16
v_fmac_f32 v10, v11, v11
v_fmac_f32 v10, v12, v12
v_lshlrev_b32 v11, 16, v17
v_and_b32 v12, 0xffff0000, v17
v_fmac_f32 v10, v11, v11
v_fmac_f32 v10, v12, v12
v_lshlrev_b32 v11, 16, v18
v_and_b32 v12, 0xffff0000, v18
v_fmac_f32 v10, v11, v11
v_fmac_f32 v10, v12, v12
v_lshlrev_b32 v11, 16, v19
v_and_b32 v12, 0xffff0000, v19
v_fmac_f32 v10, v11, v11
v_fmac_f32 v10, v12, v12
v_mov_b32 v11, v10
s_nop 1
v_permlane32_swap_b32 v10, v11
s_nop 1
v_add_f32 v10, v10, v11
v_mul_f32 v10, v10, v5
v_sqrt_f32 v10, v10
s_nop 0
v_mul_f32 v32, 0xbf800347, v10
v_mov_b32 v33, v32
v_mov_b32 v34, v32
v_mov_b32 v35, v32
v_mov_b32 v36, v32
v_mov_b32 v37, v32
v_mov_b32 v38, v32
v_mov_b32 v39, v32
v_mov_b32 v40, v32
v_mov_b32 v41, v32
v_mov_b32 v42, v32
v_mov_b32 v43, v32
v_mov_b32 v44, v32
v_mov_b32 v45, v32
v_mov_b32 v46, v32
v_mov_b32 v47, v32
v_mov_b32 v10, 0
v_lshlrev_b32 v11, 16, v20
v_and_b32 v12, 0xffff0000, v20
v_fmac_f32 v10, v11, v11
v_fmac_f32 v10, v12, v12
v_lshlrev_b32 v11, 16, v21
v_and_b32 v12, 0xffff0000, v21
v_fmac_f32 v10, v11, v11
v_fmac_f32 v10, v12, v12
v_lshlrev_b32 v11, 16, v22
v_and_b32 v12, 0xffff0000, v22
v_fmac_f32 v10, v11, v11
v_fmac_f32 v10, v12, v12
v_lshlrev_b32 v11, 16, v23
v_and_b32 v12, 0xffff0000, v23
v_fmac_f32 v10, v11, v11
v_fmac_f32 v10, v12, v12
v_mov_b32 v11, v10
s_nop 1
v_permlane32_swap_b32 v10, v11
s_nop 1
v_add_f32 v10, v10, v11
v_mul_f32 v10, v10, v5
v_sqrt_f32 v10, v10
s_nop 0
v_mul_f32 v48, 0xbf800347, v10
v_mov_b32 v49, v48
v_mov_b32 v50, v48
v_mov_b32 v51, v48
v_mov_b32 v52, v48
v_mov_b32 v53, v48
v_mov_b32 v54, v48
v_mov_b32 v55, v48
v_mov_b32 v56, v48
v_mov_b32 v57, v48
v_mov_b32 v58, v48
v_mov_b32 v59, v48
v_mov_b32 v60, v48
v_mov_b32 v61, v48
v_mov_b32 v62, v48
v_mov_b32 v63, v48
v_min_f32 v10, v32, v48
v_cmp_nle_f32 vcc, 0xc2480000, v10
s_mov_b32 s28, 0
s_waitcnt vmcnt(0)
s_barrier
s_setprio 0
s_cbranch_vccnz K2_SLOW
ds_read_b128 v[144:147], v7
ds_read_b128 v[148:151], v7 offset:1024
s_mov_b64 exec, s[30:31]
ds_read_b128 v[160:163], v6
ds_read_b128 v[164:167], v6 offset:512
s_mov_b64 exec, -1
s_waitcnt lgkmcnt(0)
v_mfma_f32_32x32x16_bf16 v[64:79], v[144:147], v[16:19], v[32:47]
s_nop 7
s_nop 3
.p2align 4
K2_LOOP:
v_mfma_f32_32x32x16_bf16 v[80:95], v[144:147], v[20:23], v[48:63]
ds_read_b128 v[152:155], v7 offset:2048
s_mov_b64 exec, s[30:31]
ds_read_b128 v[168:171], v6 offset:1024
ds_read_b128 v[172:175], v6 offset:1536
s_mov_b64 exec, -1
v_exp_f32 v64, v64
v_exp_f32 v65, v65
v_exp_f32 v66, v66
v_exp_f32 v67, v67
v_mfma_f32_32x32x16_bf16 v[128:143], v[184:187], v[104:107], v[128:143]
v_cvt_pk_bf16_f32 v96, v64, v65
v_exp_f32 v68, v68
v_exp_f32 v69, v69
v_cvt_pk_bf16_f32 v97, v66, v67
v_exp_f32 v70, v70
v_exp_f32 v71, v71
v_cvt_pk_bf16_f32 v98, v68, v69
v_mfma_f32_32x32x16_bf16 v[128:143], v[188:191], v[108:111], v[128:143]
v_exp_f32 v72, v72
v_exp_f32 v73, v73
v_cvt_pk_bf16_f32 v99, v70, v71
v_exp_f32 v74, v74
v_exp_f32 v75, v75
v_cvt_pk_bf16_f32 v100, v72, v73
v_exp_f32 v76, v76
v_exp_f32 v77, v77
v_exp_f32 v78, v78
v_exp_f32 v79, v79
v_cvt_pk_bf16_f32 v101, v74, v75
v_cvt_pk_bf16_f32 v102, v76, v77
v_cvt_pk_bf16_f32 v103, v78, v79
s_waitcnt lgkmcnt(3)
v_mfma_f32_32x32x16_bf16 v[64:79], v[148:151], v[16:19], v[32:47]
v_exp_f32 v80, v80
v_exp_f32 v81, v81
v_exp_f32 v82, v82
v_exp_f32 v83, v83
v_mfma_f32_32x32x16_bf16 v[112:127], v[160:163], v[96:99], v[112:127]
v_cvt_pk_bf16_f32 v104, v80, v81
v_exp_f32 v84, v84
v_exp_f32 v85, v85
v_cvt_pk_bf16_f32 v105, v82, v83
v_exp_f32 v86, v86
v_exp_f32 v87, v87
v_cvt_pk_bf16_f32 v106, v84, v85
v_mfma_f32_32x32x16_bf16 v[112:127], v[164:167], v[100:103], v[112:127]
v_exp_f32 v88, v88
v_exp_f32 v89, v89
v_cvt_pk_bf16_f32 v107, v86, v87
v_exp_f32 v90, v90
v_exp_f32 v91, v91
v_cvt_pk_bf16_f32 v108, v88, v89
v_exp_f32 v92, v92
v_exp_f32 v93, v93
v_exp_f32 v94, v94
v_exp_f32 v95, v95
v_cvt_pk_bf16_f32 v109, v90, v91
v_cvt_pk_bf16_f32 v110, v92, v93
v_cvt_pk_bf16_f32 v111, v94, v95
v_mfma_f32_32x32x16_bf16 v[80:95], v[148:151], v[20:23], v[48:63]
ds_read_b128 v[156:159], v7 offset:3072
s_mov_b64 exec, s[30:31]
ds_read_b128 v[176:179], v6 offset:2048
ds_read_b128 v[180:183], v6 offset:2560
s_mov_b64 exec, -1
v_exp_f32 v64, v64
v_exp_f32 v65, v65
v_exp_f32 v66, v66
v_exp_f32 v67, v67
v_mfma_f32_32x32x16_bf16 v[128:143], v[160:163], v[104:107], v[128:143]
v_cvt_pk_bf16_f32 v96, v64, v65
v_exp_f32 v68, v68
v_exp_f32 v69, v69
v_cvt_pk_bf16_f32 v97, v66, v67
v_exp_f32 v70, v70
v_exp_f32 v71, v71
v_cvt_pk_bf16_f32 v98, v68, v69
v_mfma_f32_32x32x16_bf16 v[128:143], v[164:167], v[108:111], v[128:143]
v_exp_f32 v72, v72
v_exp_f32 v73, v73
v_cvt_pk_bf16_f32 v99, v70, v71
v_exp_f32 v74, v74
v_exp_f32 v75, v75
v_cvt_pk_bf16_f32 v100, v72, v73
v_exp_f32 v76, v76
v_exp_f32 v77, v77
v_exp_f32 v78, v78
v_exp_f32 v79, v79
v_cvt_pk_bf16_f32 v101, v74, v75
v_cvt_pk_bf16_f32 v102, v76, v77
v_cvt_pk_bf16_f32 v103, v78, v79
s_waitcnt lgkmcnt(3)
v_mfma_f32_32x32x16_bf16 v[64:79], v[152:155], v[16:19], v[32:47]
v_exp_f32 v80, v80
v_exp_f32 v81, v81
v_exp_f32 v82, v82
v_exp_f32 v83, v83
v_mfma_f32_32x32x16_bf16 v[112:127], v[168:171], v[96:99], v[112:127]
v_cvt_pk_bf16_f32 v104, v80, v81
v_exp_f32 v84, v84
v_exp_f32 v85, v85
v_cvt_pk_bf16_f32 v105, v82, v83
v_exp_f32 v86, v86
v_exp_f32 v87, v87
v_cvt_pk_bf16_f32 v106, v84, v85
v_mfma_f32_32x32x16_bf16 v[112:127], v[172:175], v[100:103], v[112:127]
v_exp_f32 v88, v88
v_exp_f32 v89, v89
v_cvt_pk_bf16_f32 v107, v86, v87
v_exp_f32 v90, v90
v_exp_f32 v91, v91
v_cvt_pk_bf16_f32 v108, v88, v89
v_exp_f32 v92, v92
v_exp_f32 v93, v93
v_exp_f32 v94, v94
v_exp_f32 v95, v95
v_cvt_pk_bf16_f32 v109, v90, v91
v_cvt_pk_bf16_f32 v110, v92, v93
v_cvt_pk_bf16_f32 v111, v94, v95
v_mfma_f32_32x32x16_bf16 v[80:95], v[152:155], v[20:23], v[48:63]
ds_read_b128 v[144:147], v7 offset:4096
s_mov_b64 exec, s[30:31]
ds_read_b128 v[184:187], v6 offset:3072
ds_read_b128 v[188:191], v6 offset:3584
s_mov_b64 exec, -1
v_exp_f32 v64, v64
v_exp_f32 v65, v65
v_exp_f32 v66, v66
v_exp_f32 v67, v67
v_mfma_f32_32x32x16_bf16 v[128:143], v[168:171], v[104:107], v[128:143]
v_cvt_pk_bf16_f32 v96, v64, v65
v_exp_f32 v68, v68
v_exp_f32 v69, v69
v_cvt_pk_bf16_f32 v97, v66, v67
v_exp_f32 v70, v70
v_exp_f32 v71, v71
v_cvt_pk_bf16_f32 v98, v68, v69
v_mfma_f32_32x32x16_bf16 v[128:143], v[172:175], v[108:111], v[128:143]
v_exp_f32 v72, v72
v_exp_f32 v73, v73
v_cvt_pk_bf16_f32 v99, v70, v71
v_exp_f32 v74, v74
v_exp_f32 v75, v75
v_cvt_pk_bf16_f32 v100, v72, v73
v_exp_f32 v76, v76
v_exp_f32 v77, v77
v_exp_f32 v78, v78
v_exp_f32 v79, v79
v_cvt_pk_bf16_f32 v101, v74, v75
v_cvt_pk_bf16_f32 v102, v76, v77
v_cvt_pk_bf16_f32 v103, v78, v79
s_waitcnt lgkmcnt(3)
v_mfma_f32_32x32x16_bf16 v[64:79], v[156:159], v[16:19], v[32:47]
v_exp_f32 v80, v80
v_exp_f32 v81, v81
v_exp_f32 v82, v82
v_exp_f32 v83, v83
v_mfma_f32_32x32x16_bf16 v[112:127], v[176:179], v[96:99], v[112:127]
v_cvt_pk_bf16_f32 v104, v80, v81
v_exp_f32 v84, v84
v_exp_f32 v85, v85
v_cvt_pk_bf16_f32 v105, v82, v83
v_exp_f32 v86, v86
v_exp_f32 v87, v87
v_cvt_pk_bf16_f32 v106, v84, v85
v_mfma_f32_32x32x16_bf16 v[112:127], v[180:183], v[100:103], v[112:127]
v_exp_f32 v88, v88
v_exp_f32 v89, v89
v_cvt_pk_bf16_f32 v107, v86, v87
v_exp_f32 v90, v90
v_exp_f32 v91, v91
v_cvt_pk_bf16_f32 v108, v88, v89
v_exp_f32 v92, v92
v_exp_f32 v93, v93
v_exp_f32 v94, v94
v_exp_f32 v95, v95
v_cvt_pk_bf16_f32 v109, v90, v91
v_cvt_pk_bf16_f32 v110, v92, v93
v_cvt_pk_bf16_f32 v111, v94, v95
v_mfma_f32_32x32x16_bf16 v[80:95], v[156:159], v[20:23], v[48:63]
ds_read_b128 v[148:151], v7 offset:5120
s_mov_b64 exec, s[30:31]
ds_read_b128 v[160:163], v6 offset:4096
ds_read_b128 v[164:167], v6 offset:4608
s_mov_b64 exec, -1
v_exp_f32 v64, v64
v_exp_f32 v65, v65
v_exp_f32 v66, v66
v_exp_f32 v67, v67
v_mfma_f32_32x32x16_bf16 v[128:143], v[176:179], v[104:107], v[128:143]
v_cvt_pk_bf16_f32 v96, v64, v65
v_exp_f32 v68, v68
v_exp_f32 v69, v69
v_cvt_pk_bf16_f32 v97, v66, v67
v_exp_f32 v70, v70
v_exp_f32 v71, v71
v_cvt_pk_bf16_f32 v98, v68, v69
v_mfma_f32_32x32x16_bf16 v[128:143], v[180:183], v[108:111], v[128:143]
v_exp_f32 v72, v72
v_exp_f32 v73, v73
v_cvt_pk_bf16_f32 v99, v70, v71
v_exp_f32 v74, v74
v_exp_f32 v75, v75
v_cvt_pk_bf16_f32 v100, v72, v73
v_exp_f32 v76, v76
v_exp_f32 v77, v77
v_exp_f32 v78, v78
v_exp_f32 v79, v79
v_cvt_pk_bf16_f32 v101, v74, v75
v_cvt_pk_bf16_f32 v102, v76, v77
v_cvt_pk_bf16_f32 v103, v78, v79
s_waitcnt lgkmcnt(3)
v_mfma_f32_32x32x16_bf16 v[64:79], v[144:147], v[16:19], v[32:47]
v_add_u32 v6, 4096, v6
v_add_u32 v7, 4096, v7
s_add_u32 s28, s28, 1
v_exp_f32 v80, v80
v_exp_f32 v81, v81
v_exp_f32 v82, v82
v_exp_f32 v83, v83
v_mfma_f32_32x32x16_bf16 v[112:127], v[184:187], v[96:99], v[112:127]
v_cvt_pk_bf16_f32 v104, v80, v81
v_exp_f32 v84, v84
v_exp_f32 v85, v85
v_cvt_pk_bf16_f32 v105, v82, v83
v_exp_f32 v86, v86
v_exp_f32 v87, v87
v_cvt_pk_bf16_f32 v106, v84, v85
v_mfma_f32_32x32x16_bf16 v[112:127], v[188:191], v[100:103], v[112:127]
v_exp_f32 v88, v88
v_exp_f32 v89, v89
v_cvt_pk_bf16_f32 v107, v86, v87
v_exp_f32 v90, v90
v_exp_f32 v91, v91
v_cvt_pk_bf16_f32 v108, v88, v89
v_exp_f32 v92, v92
v_exp_f32 v93, v93
v_exp_f32 v94, v94
v_exp_f32 v95, v95
v_cvt_pk_bf16_f32 v109, v90, v91
v_cvt_pk_bf16_f32 v110, v92, v93
v_cvt_pk_bf16_f32 v111, v94, v95
s_cmp_lg_u32 s28, 3
s_cbranch_scc1 K2_NB
s_barrier
K2_NB:
s_cmp_lt_u32 s28, 16
s_cbranch_scc1 K2_LOOP
s_nop 0
v_mfma_f32_32x32x16_bf16 v[128:143], v[184:187], v[104:107], v[128:143]
v_mfma_f32_32x32x16_bf16 v[128:143], v[188:191], v[108:111], v[128:143]
K2_FIN:
s_nop 15
v_rcp_f32 v10, v120
v_rcp_f32 v11, v136
s_lshl_b32 s29, s24, 11
s_add_u32 s29, s29, 153600
v_add_u32 v12, s29, v9
v_mul_f32 v112, v112, v10
v_mul_f32 v113, v113, v10
v_mul_f32 v114, v114, v10
v_mul_f32 v115, v115, v10
v_mul_f32 v116, v116, v10
v_mul_f32 v117, v117, v10
v_mul_f32 v118, v118, v10
v_mul_f32 v119, v119, v10
v_cvt_pk_bf16_f32 v112, v112, v113
v_cvt_pk_bf16_f32 v113, v114, v115
v_cvt_pk_bf16_f32 v114, v116, v117
v_cvt_pk_bf16_f32 v115, v118, v119
v_mul_f32 v128, v128, v11
v_mul_f32 v129, v129, v11
v_mul_f32 v130, v130, v11
v_mul_f32 v131, v131, v11
v_mul_f32 v132, v132, v11
v_mul_f32 v133, v133, v11
v_mul_f32 v134, v134, v11
v_mul_f32 v135, v135, v11
v_cvt_pk_bf16_f32 v128, v128, v129
v_cvt_pk_bf16_f32 v129, v130, v131
v_cvt_pk_bf16_f32 v130, v132, v133
v_cvt_pk_bf16_f32 v131, v134, v135
ds_write_b128 v12, v[112:115]
ds_write_b128 v12, v[128:131] offset:1024
s_waitcnt lgkmcnt(0)
s_barrier
s_endpgm
K2_SLOW:
s_waitcnt vmcnt(0)
s_barrier
v_mov_b32 v13, 0xff61b1e6
v_mov_b32 v14, 0xff61b1e6
K2_SLOOP:
ds_read_b128 v[144:147], v7
s_mov_b64 exec, s[30:31]
ds_read_b128 v[160:163], v6
ds_read_b128 v[164:167], v6 offset:512
s_mov_b64 exec, -1
s_waitcnt lgkmcnt(0)
v_mfma_f32_32x32x16_bf16 v[64:79], v[144:147], v[16:19], 0
s_nop 15
v_max3_f32 v10, v64, v65, v13
v_max3_f32 v10, v66, v67, v10
v_max3_f32 v10, v68, v69, v10
v_max3_f32 v10, v70, v71, v10
v_max3_f32 v10, v72, v73, v10
v_max3_f32 v10, v74, v75, v10
v_max3_f32 v10, v76, v77, v10
v_max3_f32 v10, v78, v79, v10
v_mov_b32 v11, v10
s_nop 1
v_permlane32_swap_b32 v10, v11
s_nop 1
v_max_f32 v10, v10, v11
v_sub_f32 v11, v13, v10
v_exp_f32 v11, v11
v_mov_b32 v13, v10
v_sub_f32 v64, v64, v10
v_exp_f32 v64, v64
v_mul_f32 v112, v112, v11
v_sub_f32 v65, v65, v10
v_exp_f32 v65, v65
v_mul_f32 v113, v113, v11
v_sub_f32 v66, v66, v10
v_exp_f32 v66, v66
v_mul_f32 v114, v114, v11
v_sub_f32 v67, v67, v10
v_exp_f32 v67, v67
v_mul_f32 v115, v115, v11
v_sub_f32 v68, v68, v10
v_exp_f32 v68, v68
v_mul_f32 v116, v116, v11
v_sub_f32 v69, v69, v10
v_exp_f32 v69, v69
v_mul_f32 v117, v117, v11
v_sub_f32 v70, v70, v10
v_exp_f32 v70, v70
v_mul_f32 v118, v118, v11
v_sub_f32 v71, v71, v10
v_exp_f32 v71, v71
v_mul_f32 v119, v119, v11
v_sub_f32 v72, v72, v10
v_exp_f32 v72, v72
v_mul_f32 v120, v120, v11
v_sub_f32 v73, v73, v10
v_exp_f32 v73, v73
v_mul_f32 v121, v121, v11
v_sub_f32 v74, v74, v10
v_exp_f32 v74, v74
v_mul_f32 v122, v122, v11
v_sub_f32 v75, v75, v10
v_exp_f32 v75, v75
v_mul_f32 v123, v123, v11
v_sub_f32 v76, v76, v10
v_exp_f32 v76, v76
v_mul_f32 v124, v124, v11
v_sub_f32 v77, v77, v10
v_exp_f32 v77, v77
v_mul_f32 v125, v125, v11
v_sub_f32 v78, v78, v10
v_exp_f32 v78, v78
v_mul_f32 v126, v126, v11
v_sub_f32 v79, v79, v10
v_exp_f32 v79, v79
v_mul_f32 v127, v127, v11
v_cvt_pk_bf16_f32 v96, v64, v65
v_cvt_pk_bf16_f32 v97, v66, v67
v_cvt_pk_bf16_f32 v98, v68, v69
v_cvt_pk_bf16_f32 v99, v70, v71
v_cvt_pk_bf16_f32 v100, v72, v73
v_cvt_pk_bf16_f32 v101, v74, v75
v_cvt_pk_bf16_f32 v102, v76, v77
v_cvt_pk_bf16_f32 v103, v78, v79
s_nop 1
v_mfma_f32_32x32x16_bf16 v[112:127], v[160:163], v[96:99], v[112:127]
v_mfma_f32_32x32x16_bf16 v[112:127], v[164:167], v[100:103], v[112:127]
s_nop 15
v_mfma_f32_32x32x16_bf16 v[64:79], v[144:147], v[20:23], 0
s_nop 15
v_max3_f32 v10, v64, v65, v14
v_max3_f32 v10, v66, v67, v10
v_max3_f32 v10, v68, v69, v10
v_max3_f32 v10, v70, v71, v10
v_max3_f32 v10, v72, v73, v10
v_max3_f32 v10, v74, v75, v10
v_max3_f32 v10, v76, v77, v10
v_max3_f32 v10, v78, v79, v10
v_mov_b32 v11, v10
s_nop 1
v_permlane32_swap_b32 v10, v11
s_nop 1
v_max_f32 v10, v10, v11
v_sub_f32 v11, v14, v10
v_exp_f32 v11, v11
v_mov_b32 v14, v10
v_sub_f32 v64, v64, v10
v_exp_f32 v64, v64
v_mul_f32 v128, v128, v11
v_sub_f32 v65, v65, v10
v_exp_f32 v65, v65
v_mul_f32 v129, v129, v11
v_sub_f32 v66, v66, v10
v_exp_f32 v66, v66
v_mul_f32 v130, v130, v11
v_sub_f32 v67, v67, v10
v_exp_f32 v67, v67
v_mul_f32 v131, v131, v11
v_sub_f32 v68, v68, v10
v_exp_f32 v68, v68
v_mul_f32 v132, v132, v11
v_sub_f32 v69, v69, v10
v_exp_f32 v69, v69
v_mul_f32 v133, v133, v11
v_sub_f32 v70, v70, v10
v_exp_f32 v70, v70
v_mul_f32 v134, v134, v11
v_sub_f32 v71, v71, v10
v_exp_f32 v71, v71
v_mul_f32 v135, v135, v11
v_sub_f32 v72, v72, v10
v_exp_f32 v72, v72
v_mul_f32 v136, v136, v11
v_sub_f32 v73, v73, v10
v_exp_f32 v73, v73
v_mul_f32 v137, v137, v11
v_sub_f32 v74, v74, v10
v_exp_f32 v74, v74
v_mul_f32 v138, v138, v11
v_sub_f32 v75, v75, v10
v_exp_f32 v75, v75
v_mul_f32 v139, v139, v11
v_sub_f32 v76, v76, v10
v_exp_f32 v76, v76
v_mul_f32 v140, v140, v11
v_sub_f32 v77, v77, v10
v_exp_f32 v77, v77
v_mul_f32 v141, v141, v11
v_sub_f32 v78, v78, v10
v_exp_f32 v78, v78
v_mul_f32 v142, v142, v11
v_sub_f32 v79, v79, v10
v_exp_f32 v79, v79
v_mul_f32 v143, v143, v11
v_cvt_pk_bf16_f32 v96, v64, v65
v_cvt_pk_bf16_f32 v97, v66, v67
v_cvt_pk_bf16_f32 v98, v68, v69
v_cvt_pk_bf16_f32 v99, v70, v71
v_cvt_pk_bf16_f32 v100, v72, v73
v_cvt_pk_bf16_f32 v101, v74, v75
v_cvt_pk_bf16_f32 v102, v76, v77
v_cvt_pk_bf16_f32 v103, v78, v79
s_nop 1
v_mfma_f32_32x32x16_bf16 v[128:143], v[160:163], v[96:99], v[128:143]
v_mfma_f32_32x32x16_bf16 v[128:143], v[164:167], v[100:103], v[128:143]
s_nop 15
v_add_u32 v6, 1024, v6
v_add_u32 v7, 1024, v7
s_add_u32 s28, s28, 1
s_cmp_lt_u32 s28, 64
s_cbranch_scc1 K2_SLOOP
s_branch K2_FIN
K2_FFN:
s_sub_u32 s24, s24, 4
s_mov_b32 s28, s27
buffer_load_dwordx4 v[128:131], v9, s[36:39], s28 offen offset:0
buffer_load_dwordx4 v[132:135], v9, s[36:39], s28 offen offset:1024
buffer_load_dwordx4 v[136:139], v9, s[36:39], s28 offen offset:2048
buffer_load_dwordx4 v[140:143], v9, s[36:39], s28 offen offset:3072
s_add_u32 s28, s28, 4096
buffer_load_dwordx4 v[144:147], v9, s[36:39], s28 offen offset:0
buffer_load_dwordx4 v[148:151], v9, s[36:39], s28 offen offset:1024
buffer_load_dwordx4 v[152:155], v9, s[36:39], s28 offen offset:2048
buffer_load_dwordx4 v[156:159], v9, s[36:39], s28 offen offset:3072
s_add_u32 s28, s28, 4096
s_mul_i32 s29, s26, 11
s_min_u32 s29, s29, 32
s_mov_b32 s30, s24
s_cmp_eq_u32 s26, 3
s_cselect_b32 s31, 0, 1
s_or_b32 s31, s31, s24
s_cmp_eq_u32 s31, 0
s_cselect_b32 s30, 4, s30
s_add_u32 s32, s29, s30
s_lshl_b32 s32, s32, 16
s_add_u32 s32, s32, 5242880
s_mul_i32 s33, s24, 86
s_lshl_b32 s34, s29, 1
s_add_u32 s33, s33, s34
s_lshl_b32 s33, s33, 12
s_add_u32 s33, s33, 8388608
s_lshl_b32 s34, s24, 5
s_lshl_b32 s35, s26, 3
s_add_u32 s34, s34, s35
s_lshl_b32 s34, s34, 12
s_add_u32 s34, s34, 10485760
s_mov_b32 s40, s32
v_mov_b32 v4, 0xbdd2d3e8
s_lshl_b32 s45, s24, 2
s_add_u32 s45, s45, 161792
v_mov_b32 v5, s45
v_mov_b32 v6, 161792
v_add_u32 v7, 131072, v9
v_mov_b32 v10, 0
ds_write_b32 v5, v10
s_waitcnt lgkmcnt(0)
s_barrier
buffer_load_dwordx4 v[160:163], v9, s[36:39], s28 offen offset:0
buffer_load_dwordx4 v[164:167], v9, s[36:39], s28 offen offset:1024
buffer_load_dwordx4 v[168:171], v9, s[36:39], s28 offen offset:2048
buffer_load_dwordx4 v[172:175], v9, s[36:39], s28 offen offset:3072
s_add_u32 s28, s28, 4096
buffer_load_dwordx4 v[176:179], v9, s[36:39], s28 offen offset:0
buffer_load_dwordx4 v[180:183], v9, s[36:39], s28 offen offset:1024
buffer_load_dwordx4 v[184:187], v9, s[36:39], s28 offen offset:2048
buffer_load_dwordx4 v[188:191], v9, s[36:39], s28 offen offset:3072
s_add_u32 s28, s28, 4096
buffer_load_dwordx4 v[192:195], v9, s[36:39], s28 offen offset:0
buffer_load_dwordx4 v[196:199], v9, s[36:39], s28 offen offset:1024
buffer_load_dwordx4 v[200:203], v9, s[36:39], s28 offen offset:2048
buffer_load_dwordx4 v[204:207], v9, s[36:39], s28 offen offset:3072
s_add_u32 s28, s28, 4096
buffer_load_dwordx4 v[208:211], v9, s[36:39], s28 offen offset:0
buffer_load_dwordx4 v[212:215], v9, s[36:39], s28 offen offset:1024
buffer_load_dwordx4 v[216:219], v9, s[36:39], s28 offen offset:2048
buffer_load_dwordx4 v[220:223], v9, s[36:39], s28 offen offset:3072
s_add_u32 s28, s28, 4096
buffer_load_dwordx4 v[224:227], v9, s[36:39], s28 offen offset:0
buffer_load_dwordx4 v[228:231], v9, s[36:39], s28 offen offset:1024
buffer_load_dwordx4 v[232:235], v9, s[36:39], s28 offen offset:2048
buffer_load_dwordx4 v[236:239], v9, s[36:39], s28 offen offset:3072
s_add_u32 s28, s28, 4096
buffer_load_dwordx4 v[240:243], v9, s[36:39], s28 offen offset:0
buffer_load_dwordx4 v[244:247], v9, s[36:39], s28 offen offset:1024
buffer_load_dwordx4 v[248:251], v9, s[36:39], s28 offen offset:2048
buffer_load_dwordx4 v[252:255], v9, s[36:39], s28 offen offset:3072
s_add_u32 s28, s28, 4096
buffer_load_dwordx4 v[64:67], v9, s[36:39], s40 offen offset:0
buffer_load_dwordx4 v[68:71], v9, s[36:39], s40 offen offset:1024
buffer_load_dwordx4 v[72:75], v9, s[36:39], s40 offen offset:2048
buffer_load_dwordx4 v[76:79], v9, s[36:39], s40 offen offset:3072
s_add_u32 s40, s40, 4096
buffer_load_dwordx4 v[80:83], v9, s[36:39], s40 offen offset:0
buffer_load_dwordx4 v[84:87], v9, s[36:39], s40 offen offset:1024
buffer_load_dwordx4 v[88:91], v9, s[36:39], s40 offen offset:2048
buffer_load_dwordx4 v[92:95], v9, s[36:39], s40 offen offset:3072
s_add_u32 s40, s40, 4096
buffer_load_dwordx4 v[96:99], v9, s[36:39], s40 offen offset:0
buffer_load_dwordx4 v[100:103], v9, s[36:39], s40 offen offset:1024
buffer_load_dwordx4 v[104:107], v9, s[36:39], s40 offen offset:2048
buffer_load_dwordx4 v[108:111], v9, s[36:39], s40 offen offset:3072
s_add_u32 s40, s40, 4096
buffer_load_dwordx4 v[112:115], v9, s[36:39], s40 offen offset:0
buffer_load_dwordx4 v[116:119], v9, s[36:39], s40 offen offset:1024
buffer_load_dwordx4 v[120:123], v9, s[36:39], s40 offen offset:2048
buffer_load_dwordx4 v[124:127], v9, s[36:39], s40 offen offset:3072
s_add_u32 s40, s40, 4096
s_lshl_b32 s46, s24, 10
s_add_u32 s46, s46, 16384
s_mov_b32 m0, s46
s_add_u32 s46, s46, 4194304
s_nop 0
buffer_load_dwordx4 v9, s[36:39], s46 offen lds
s_add_u32 m0, m0, 65536
s_add_u32 s46, s46, 65536
s_nop 0
buffer_load_dwordx4 v9, s[36:39], s46 offen lds
s_sub_u32 m0, m0, 61440
s_sub_u32 s46, s46, 61440
s_nop 0
buffer_load_dwordx4 v9, s[36:39], s46 offen lds
s_add_u32 m0, m0, 65536
s_add_u32 s46, s46, 65536
s_nop 0
buffer_load_dwordx4 v9, s[36:39], s46 offen lds
s_sub_u32 m0, m0, 61440
s_sub_u32 s46, s46, 61440
s_nop 0
buffer_load_dwordx4 v9, s[36:39], s46 offen lds
s_add_u32 m0, m0, 65536
s_add_u32 s46, s46, 65536
s_nop 0
buffer_load_dwordx4 v9, s[36:39], s46 offen lds
s_sub_u32 m0, m0, 61440
s_sub_u32 s46, s46, 61440
s_nop 0
buffer_load_dwordx4 v9, s[36:39], s46 offen lds
s_add_u32 m0, m0, 65536
s_add_u32 s46, s46, 65536
s_nop 0
buffer_load_dwordx4 v9, s[36:39], s46 offen lds
s_sub_u32 m0, m0, 61440
s_sub_u32 s46, s46, 61440
s_nop 0
buffer_load_dwordx4 v9, s[36:39], s46 offen lds
s_add_u32 m0, m0, 65536
s_add_u32 s46, s46, 65536
s_nop 0
buffer_load_dwordx4 v9, s[36:39], s46 offen lds
s_sub_u32 m0, m0, 61440
s_sub_u32 s46, s46, 61440
s_nop 0
buffer_load_dwordx4 v9, s[36:39], s46 offen lds
s_add_u32 m0, m0, 65536
s_add_u32 s46, s46, 65536
s_nop 0
buffer_load_dwordx4 v9, s[36:39], s46 offen lds
s_sub_u32 m0, m0, 61440
s_sub_u32 s46, s46, 61440
s_nop 0
buffer_load_dwordx4 v9, s[36:39], s46 offen lds
s_add_u32 m0, m0, 65536
s_add_u32 s46, s46, 65536
s_nop 0
buffer_load_dwordx4 v9, s[36:39], s46 offen lds
s_sub_u32 m0, m0, 61440
s_sub_u32 s46, s46, 61440
s_nop 0
buffer_load_dwordx4 v9, s[36:39], s46 offen lds
s_add_u32 m0, m0, 65536
s_add_u32 s46, s46, 65536
s_nop 0
buffer_load_dwordx4 v9, s[36:39], s46 offen lds
s_sub_u32 m0, m0, 61440
s_sub_u32 s46, s46, 61440
s_nop 0
buffer_load_dwordx4 v9, s[36:39], s46 offen lds
s_add_u32 m0, m0, 65536
s_add_u32 s46, s46, 65536
s_nop 0
buffer_load_dwordx4 v9, s[36:39], s46 offen lds
s_sub_u32 m0, m0, 61440
s_sub_u32 s46, s46, 61440
s_nop 0
buffer_load_dwordx4 v9, s[36:39], s46 offen lds
s_add_u32 m0, m0, 65536
s_add_u32 s46, s46, 65536
s_nop 0
buffer_load_dwordx4 v9, s[36:39], s46 offen lds
s_sub_u32 m0, m0, 61440
s_sub_u32 s46, s46, 61440
s_nop 0
buffer_load_dwordx4 v9, s[36:39], s46 offen lds
s_add_u32 m0, m0, 65536
s_add_u32 s46, s46, 65536
s_nop 0
buffer_load_dwordx4 v9, s[36:39], s46 offen lds
s_sub_u32 m0, m0, 61440
s_sub_u32 s46, s46, 61440
s_nop 0
buffer_load_dwordx4 v9, s[36:39], s46 offen lds
s_add_u32 m0, m0, 65536
s_add_u32 s46, s46, 65536
s_nop 0
buffer_load_dwordx4 v9, s[36:39], s46 offen lds
s_sub_u32 m0, m0, 61440
s_sub_u32 s46, s46, 61440
s_setprio 2
s_mov_b32 s44, 0
.p2align 4
K2_FLOOP:
s_add_u32 s41, s30, 4
s_add_u32 s42, s32, 262144
s_cmp_lt_u32 s41, 11
s_cselect_b32 s42, s42, s33
s_waitcnt vmcnt(15)
v_mfma_f32_32x32x16_bf16 v[16:31], v[64:67], v[128:131], 0
buffer_load_dwordx4 v[64:67], v9, s[36:39], s40 offen offset:0
s_waitcnt vmcnt(15)
v_mfma_f32_32x32x16_bf16 v[32:47], v[68:71], v[128:131], 0
buffer_load_dwordx4 v[68:71], v9, s[36:39], s40 offen offset:1024
s_waitcnt vmcnt(15)
v_mfma_f32_32x32x16_bf16 v[16:31], v[72:75], v[132:135], v[16:31]
buffer_load_dwordx4 v[72:75], v9, s[36:39], s40 offen offset:2048
s_waitcnt vmcnt(15)
v_mfma_f32_32x32x16_bf16 v[32:47], v[76:79], v[132:135], v[32:47]
buffer_load_dwordx4 v[76:79], v9, s[36:39], s40 offen offset:3072
s_add_u32 s40, s40, 4096
s_waitcnt vmcnt(15)
v_mfma_f32_32x32x16_bf16 v[16:31], v[80:83], v[136:139], v[16:31]
buffer_load_dwordx4 v[80:83], v9, s[36:39], s40 offen offset:0
s_waitcnt vmcnt(15)
v_mfma_f32_32x32x16_bf16 v[32:47], v[84:87], v[136:139], v[32:47]
buffer_load_dwordx4 v[84:87], v9, s[36:39], s40 offen offset:1024
s_waitcnt vmcnt(15)
v_mfma_f32_32x32x16_bf16 v[16:31], v[88:91], v[140:143], v[16:31]
buffer_load_dwordx4 v[88:91], v9, s[36:39], s40 offen offset:2048
s_waitcnt vmcnt(15)
v_mfma_f32_32x32x16_bf16 v[32:47], v[92:95], v[140:143], v[32:47]
buffer_load_dwordx4 v[92:95], v9, s[36:39], s40 offen offset:3072
s_add_u32 s40, s40, 4096
s_waitcnt vmcnt(15)
v_mfma_f32_32x32x16_bf16 v[16:31], v[96:99], v[144:147], v[16:31]
buffer_load_dwordx4 v[96:99], v9, s[36:39], s40 offen offset:0
s_waitcnt vmcnt(15)
v_mfma_f32_32x32x16_bf16 v[32:47], v[100:103], v[144:147], v[32:47]
buffer_load_dwordx4 v[100:103], v9, s[36:39], s40 offen offset:1024
s_waitcnt vmcnt(15)
v_mfma_f32_32x32x16_bf16 v[16:31], v[104:107], v[148:151], v[16:31]
buffer_load_dwordx4 v[104:107], v9, s[36:39], s40 offen offset:2048
s_waitcnt vmcnt(15)
v_mfma_f32_32x32x16_bf16 v[32:47], v[108:111], v[148:151], v[32:47]
buffer_load_dwordx4 v[108:111], v9, s[36:39], s40 offen offset:3072
s_add_u32 s40, s40, 4096
s_waitcnt vmcnt(15)
v_mfma_f32_32x32x16_bf16 v[16:31], v[112:115], v[152:155], v[16:31]
buffer_load_dwordx4 v[112:115], v9, s[36:39], s40 offen offset:0
s_waitcnt vmcnt(15)
v_mfma_f32_32x32x16_bf16 v[32:47], v[116:119], v[152:155], v[32:47]
buffer_load_dwordx4 v[116:119], v9, s[36:39], s40 offen offset:1024
s_waitcnt vmcnt(15)
v_mfma_f32_32x32x16_bf16 v[16:31], v[120:123], v[156:159], v[16:31]
buffer_load_dwordx4 v[120:123], v9, s[36:39], s40 offen offset:2048
s_waitcnt vmcnt(15)
v_mfma_f32_32x32x16_bf16 v[32:47], v[124:127], v[156:159], v[32:47]
buffer_load_dwordx4 v[124:127], v9, s[36:39], s40 offen offset:3072
s_add_u32 s40, s40, 4096
s_waitcnt vmcnt(15)
s_cmp_lg_u32 s44, 0
s_cbranch_scc1 K2_FB2
s_barrier
K2_FB2:
v_mfma_f32_32x32x16_bf16 v[16:31], v[64:67], v[160:163], v[16:31]
buffer_load_dwordx4 v[64:67], v9, s[36:39], s40 offen offset:0
s_waitcnt vmcnt(15)
v_mfma_f32_32x32x16_bf16 v[32:47], v[68:71], v[160:163], v[32:47]
buffer_load_dwordx4 v[68:71], v9, s[36:39], s40 offen offset:1024
s_waitcnt vmcnt(15)
v_mfma_f32_32x32x16_bf16 v[16:31], v[72:75], v[164:167], v[16:31]
buffer_load_dwordx4 v[72:75], v9, s[36:39], s40 offen offset:2048
s_waitcnt vmcnt(15)
v_mfma_f32_32x32x16_bf16 v[32:47], v[76:79], v[164:167], v[32:47]
buffer_load_dwordx4 v[76:79], v9, s[36:39], s40 offen offset:3072
s_add_u32 s40, s40, 4096
s_waitcnt vmcnt(15)
v_mfma_f32_32x32x16_bf16 v[16:31], v[80:83], v[168:171], v[16:31]
buffer_load_dwordx4 v[80:83], v9, s[36:39], s40 offen offset:0
s_waitcnt vmcnt(15)
v_mfma_f32_32x32x16_bf16 v[32:47], v[84:87], v[168:171], v[32:47]
buffer_load_dwordx4 v[84:87], v9, s[36:39], s40 offen offset:1024
s_waitcnt vmcnt(15)
v_mfma_f32_32x32x16_bf16 v[16:31], v[88:91], v[172:175], v[16:31]
buffer_load_dwordx4 v[88:91], v9, s[36:39], s40 offen offset:2048
s_waitcnt vmcnt(15)
v_mfma_f32_32x32x16_bf16 v[32:47], v[92:95], v[172:175], v[32:47]
buffer_load_dwordx4 v[92:95], v9, s[36:39], s40 offen offset:3072
s_add_u32 s40, s40, 4096
s_waitcnt vmcnt(15)
v_mfma_f32_32x32x16_bf16 v[16:31], v[96:99], v[176:179], v[16:31]
buffer_load_dwordx4 v[96:99], v9, s[36:39], s40 offen offset:0
s_waitcnt vmcnt(15)
v_mfma_f32_32x32x16_bf16 v[32:47], v[100:103], v[176:179], v[32:47]
buffer_load_dwordx4 v[100:103], v9, s[36:39], s40 offen offset:1024
s_waitcnt vmcnt(15)
v_mfma_f32_32x32x16_bf16 v[16:31], v[104:107], v[180:183], v[16:31]
buffer_load_dwordx4 v[104:107], v9, s[36:39], s40 offen offset:2048
s_waitcnt vmcnt(15)
v_mfma_f32_32x32x16_bf16 v[32:47], v[108:111], v[180:183], v[32:47]
buffer_load_dwordx4 v[108:111], v9, s[36:39], s40 offen offset:3072
s_add_u32 s40, s40, 4096
s_waitcnt vmcnt(15)
v_mfma_f32_32x32x16_bf16 v[16:31], v[112:115], v[184:187], v[16:31]
buffer_load_dwordx4 v[112:115], v9, s[36:39], s40 offen offset:0
s_waitcnt vmcnt(15)
v_mfma_f32_32x32x16_bf16 v[32:47], v[116:119], v[184:187], v[32:47]
buffer_load_dwordx4 v[116:119], v9, s[36:39], s40 offen offset:1024
s_waitcnt vmcnt(15)
v_mfma_f32_32x32x16_bf16 v[16:31], v[120:123], v[188:191], v[16:31]
buffer_load_dwordx4 v[120:123], v9, s[36:39], s40 offen offset:2048
s_waitcnt vmcnt(15)
v_mfma_f32_32x32x16_bf16 v[32:47], v[124:127], v[188:191], v[32:47]
buffer_load_dwordx4 v[124:127], v9, s[36:39], s40 offen offset:3072
s_add_u32 s40, s40, 4096
s_waitcnt vmcnt(15)
v_mfma_f32_32x32x16_bf16 v[16:31], v[64:67], v[192:195], v[16:31]
buffer_load_dwordx4 v[64:67], v9, s[36:39], s40 offen offset:0
s_waitcnt vmcnt(15)
v_mfma_f32_32x32x16_bf16 v[32:47], v[68:71], v[192:195], v[32:47]
buffer_load_dwordx4 v[68:71], v9, s[36:39], s40 offen offset:1024
s_waitcnt vmcnt(15)
v_mfma_f32_32x32x16_bf16 v[16:31], v[72:75], v[196:199], v[16:31]
buffer_load_dwordx4 v[72:75], v9, s[36:39], s40 offen offset:2048
s_waitcnt vmcnt(15)
v_mfma_f32_32x32x16_bf16 v[32:47], v[76:79], v[196:199], v[32:47]
buffer_load_dwordx4 v[76:79], v9, s[36:39], s40 offen offset:3072
s_add_u32 s40, s40, 4096
s_waitcnt vmcnt(15)
v_mfma_f32_32x32x16_bf16 v[16:31], v[80:83], v[200:203], v[16:31]
buffer_load_dwordx4 v[80:83], v9, s[36:39], s40 offen offset:0
s_waitcnt vmcnt(15)
v_mfma_f32_32x32x16_bf16 v[32:47], v[84:87], v[200:203], v[32:47]
buffer_load_dwordx4 v[84:87], v9, s[36:39], s40 offen offset:1024
s_waitcnt vmcnt(15)
v_mfma_f32_32x32x16_bf16 v[16:31], v[88:91], v[204:207], v[16:31]
buffer_load_dwordx4 v[88:91], v9, s[36:39], s40 offen offset:2048
s_waitcnt vmcnt(15)
v_mfma_f32_32x32x16_bf16 v[32:47], v[92:95], v[204:207], v[32:47]
buffer_load_dwordx4 v[92:95], v9, s[36:39], s40 offen offset:3072
s_add_u32 s40, s40, 4096
s_waitcnt vmcnt(15)
v_mfma_f32_32x32x16_bf16 v[16:31], v[96:99], v[208:211], v[16:31]
buffer_load_dwordx4 v[96:99], v9, s[36:39], s40 offen offset:0
s_waitcnt vmcnt(15)
v_mfma_f32_32x32x16_bf16 v[32:47], v[100:103], v[208:211], v[32:47]
buffer_load_dwordx4 v[100:103], v9, s[36:39], s40 offen offset:1024
s_waitcnt vmcnt(15)
v_mfma_f32_32x32x16_bf16 v[16:31], v[104:107], v[212:215], v[16:31]
buffer_load_dwordx4 v[104:107], v9, s[36:39], s40 offen offset:2048
s_waitcnt vmcnt(15)
v_mfma_f32_32x32x16_bf16 v[32:47], v[108:111], v[212:215], v[32:47]
buffer_load_dwordx4 v[108:111], v9, s[36:39], s40 offen offset:3072
s_add_u32 s40, s40, 4096
s_waitcnt vmcnt(15)
v_mfma_f32_32x32x16_bf16 v[16:31], v[112:115], v[216:219], v[16:31]
buffer_load_dwordx4 v[112:115], v9, s[36:39], s40 offen offset:0
s_waitcnt vmcnt(15)
v_mfma_f32_32x32x16_bf16 v[32:47], v[116:119], v[216:219], v[32:47]
buffer_load_dwordx4 v[116:119], v9, s[36:39], s40 offen offset:1024
s_waitcnt vmcnt(15)
v_mfma_f32_32x32x16_bf16 v[16:31], v[120:123], v[220:223], v[16:31]
buffer_load_dwordx4 v[120:123], v9, s[36:39], s40 offen offset:2048
s_waitcnt vmcnt(15)
v_mfma_f32_32x32x16_bf16 v[32:47], v[124:127], v[220:223], v[32:47]
buffer_load_dwordx4 v[124:127], v9, s[36:39], s40 offen offset:3072
s_add_u32 s40, s40, 4096
s_waitcnt vmcnt(15)
v_mfma_f32_32x32x16_bf16 v[16:31], v[64:67], v[224:227], v[16:31]
s_mov_b32 s40, s42
buffer_load_dwordx4 v[64:67], v9, s[36:39], s40 offen offset:0
s_waitcnt vmcnt(15)
v_mfma_f32_32x32x16_bf16 v[32:47], v[68:71], v[224:227], v[32:47]
buffer_load_dwordx4 v[68:71], v9, s[36:39], s40 offen offset:1024
s_waitcnt vmcnt(15)
v_mfma_f32_32x32x16_bf16 v[16:31], v[72:75], v[228:231], v[16:31]
buffer_load_dwordx4 v[72:75], v9, s[36:39], s40 offen offset:2048
s_waitcnt vmcnt(15)
v_mfma_f32_32x32x16_bf16 v[32:47], v[76:79], v[228:231], v[32:47]
buffer_load_dwordx4 v[76:79], v9, s[36:39], s40 offen offset:3072
s_add_u32 s40, s40, 4096
s_waitcnt vmcnt(15)
v_mfma_f32_32x32x16_bf16 v[16:31], v[80:83], v[232:235], v[16:31]
buffer_load_dwordx4 v[80:83], v9, s[36:39], s40 offen offset:0
s_waitcnt vmcnt(15)
v_mfma_f32_32x32x16_bf16 v[32:47], v[84:87], v[232:235], v[32:47]
buffer_load_dwordx4 v[84:87], v9, s[36:39], s40 offen offset:1024
s_waitcnt vmcnt(15)
v_mfma_f32_32x32x16_bf16 v[16:31], v[88:91], v[236:239], v[16:31]
buffer_load_dwordx4 v[88:91], v9, s[36:39], s40 offen offset:2048
s_waitcnt vmcnt(15)
v_mfma_f32_32x32x16_bf16 v[32:47], v[92:95], v[236:239], v[32:47]
buffer_load_dwordx4 v[92:95], v9, s[36:39], s40 offen offset:3072
s_add_u32 s40, s40, 4096
s_waitcnt vmcnt(15)
v_mfma_f32_32x32x16_bf16 v[16:31], v[96:99], v[240:243], v[16:31]
buffer_load_dwordx4 v[96:99], v9, s[36:39], s40 offen offset:0
s_waitcnt vmcnt(15)
v_mfma_f32_32x32x16_bf16 v[32:47], v[100:103], v[240:243], v[32:47]
buffer_load_dwordx4 v[100:103], v9, s[36:39], s40 offen offset:1024
s_waitcnt vmcnt(15)
v_mfma_f32_32x32x16_bf16 v[16:31], v[104:107], v[244:247], v[16:31]
buffer_load_dwordx4 v[104:107], v9, s[36:39], s40 offen offset:2048
s_waitcnt vmcnt(15)
v_mfma_f32_32x32x16_bf16 v[32:47], v[108:111], v[244:247], v[32:47]
buffer_load_dwordx4 v[108:111], v9, s[36:39], s40 offen offset:3072
s_add_u32 s40, s40, 4096
s_waitcnt vmcnt(15)
v_mfma_f32_32x32x16_bf16 v[16:31], v[112:115], v[248:251], v[16:31]
buffer_load_dwordx4 v[112:115], v9, s[36:39], s40 offen offset:0
s_waitcnt vmcnt(15)
v_mfma_f32_32x32x16_bf16 v[32:47], v[116:119], v[248:251], v[32:47]
buffer_load_dwordx4 v[116:119], v9, s[36:39], s40 offen offset:1024
s_waitcnt vmcnt(15)
v_mfma_f32_32x32x16_bf16 v[16:31], v[120:123], v[252:255], v[16:31]
buffer_load_dwordx4 v[120:123], v9, s[36:39], s40 offen offset:2048
s_waitcnt vmcnt(15)
v_mfma_f32_32x32x16_bf16 v[32:47], v[124:127], v[252:255], v[32:47]
buffer_load_dwordx4 v[124:127], v9, s[36:39], s40 offen offset:3072
s_add_u32 s40, s40, 4096
s_cmp_lg_u32 s44, 0
s_cbranch_scc1 K2_FNB
s_mov_b32 s44, 1
s_cmp_lg_u32 s31, 0
s_cbranch_scc1 K2_FNB
v_mov_b32 v10, 0
v_mov_b32 v11, 0
v_mov_b32 v12, 0
v_mov_b32 v13, 0
ds_write_b128 v7, v[10:13]
ds_write_b128 v7, v[10:13] offset:1024
K2_FNB:
s_lshl_b32 s43, s30, 11
v_add_u32 v8, s43, v7
s_nop 9
v_mul_f32 v48, v16, v16
v_mul_f32 v49, v17, v17
v_mul_f32 v50, v18, v18
v_mul_f32 v51, v19, v19
v_mul_f32 v52, v20, v20
v_mul_f32 v53, v21, v21
v_mul_f32 v54, v22, v22
v_mul_f32 v55, v23, v23
v_mul_f32 v56, v24, v24
v_mul_f32 v57, v25, v25
v_mul_f32 v58, v26, v26
v_mul_f32 v59, v27, v27
v_mul_f32 v60, v28, v28
v_mul_f32 v61, v29, v29
v_mul_f32 v62, v30, v30
v_mul_f32 v63, v31, v31
v_fmaak_f32 v48, v48, v4, 0xc0135761
v_fmaak_f32 v49, v49, v4, 0xc0135761
v_fmaak_f32 v50, v50, v4, 0xc0135761
v_fmaak_f32 v51, v51, v4, 0xc0135761
v_fmaak_f32 v52, v52, v4, 0xc0135761
v_fmaak_f32 v53, v53, v4, 0xc0135761
v_fmaak_f32 v54, v54, v4, 0xc0135761
v_fmaak_f32 v55, v55, v4, 0xc0135761
v_fmaak_f32 v56, v56, v4, 0xc0135761
v_fmaak_f32 v57, v57, v4, 0xc0135761
v_fmaak_f32 v58, v58, v4, 0xc0135761
v_fmaak_f32 v59, v59, v4, 0xc0135761
v_fmaak_f32 v60, v60, v4, 0xc0135761
v_fmaak_f32 v61, v61, v4, 0xc0135761
v_fmaak_f32 v62, v62, v4, 0xc0135761
v_fmaak_f32 v63, v63, v4, 0xc0135761
v_mul_f32 v48, v48, v16
v_mul_f32 v49, v49, v17
v_mul_f32 v50, v50, v18
v_mul_f32 v51, v51, v19
v_mul_f32 v52, v52, v20
v_mul_f32 v53, v53, v21
v_mul_f32 v54, v54, v22
v_mul_f32 v55, v55, v23
v_mul_f32 v56, v56, v24
v_mul_f32 v57, v57, v25
v_mul_f32 v58, v58, v26
v_mul_f32 v59, v59, v27
v_mul_f32 v60, v60, v28
v_mul_f32 v61, v61, v29
v_mul_f32 v62, v62, v30
v_mul_f32 v63, v63, v31
v_exp_f32 v48, v48
v_mul_f32 v16, v16, v32
v_exp_f32 v49, v49
v_mul_f32 v17, v17, v33
v_exp_f32 v50, v50
v_mul_f32 v18, v18, v34
v_exp_f32 v51, v51
v_mul_f32 v19, v19, v35
v_exp_f32 v52, v52
v_mul_f32 v20, v20, v36
v_exp_f32 v53, v53
v_mul_f32 v21, v21, v37
v_exp_f32 v54, v54
v_mul_f32 v22, v22, v38
v_exp_f32 v55, v55
v_mul_f32 v23, v23, v39
v_exp_f32 v56, v56
v_mul_f32 v24, v24, v40
v_exp_f32 v57, v57
v_mul_f32 v25, v25, v41
v_exp_f32 v58, v58
v_mul_f32 v26, v26, v42
v_exp_f32 v59, v59
v_mul_f32 v27, v27, v43
v_exp_f32 v60, v60
v_mul_f32 v28, v28, v44
v_exp_f32 v61, v61
v_mul_f32 v29, v29, v45
v_exp_f32 v62, v62
v_mul_f32 v30, v30, v46
v_exp_f32 v63, v63
v_mul_f32 v31, v31, v47
v_add_f32 v48, 1.0, v48
v_add_f32 v49, 1.0, v49
v_add_f32 v50, 1.0, v50
v_add_f32 v51, 1.0, v51
v_add_f32 v52, 1.0, v52
v_add_f32 v53, 1.0, v53
v_add_f32 v54, 1.0, v54
v_add_f32 v55, 1.0, v55
v_add_f32 v56, 1.0, v56
v_add_f32 v57, 1.0, v57
v_add_f32 v58, 1.0, v58
v_add_f32 v59, 1.0, v59
v_add_f32 v60, 1.0, v60
v_add_f32 v61, 1.0, v61
v_add_f32 v62, 1.0, v62
v_add_f32 v63, 1.0, v63
v_rcp_f32 v48, v48
v_rcp_f32 v49, v49
v_rcp_f32 v50, v50
v_rcp_f32 v51, v51
v_rcp_f32 v52, v52
v_rcp_f32 v53, v53
v_rcp_f32 v54, v54
v_rcp_f32 v55, v55
v_rcp_f32 v56, v56
v_rcp_f32 v57, v57
v_rcp_f32 v58, v58
v_rcp_f32 v59, v59
v_rcp_f32 v60, v60
v_rcp_f32 v61, v61
v_rcp_f32 v62, v62
v_rcp_f32 v63, v63
v_mul_f32 v16, v16, v48
v_mul_f32 v17, v17, v49
v_mul_f32 v18, v18, v50
v_mul_f32 v19, v19, v51
v_mul_f32 v20, v20, v52
v_mul_f32 v21, v21, v53
v_mul_f32 v22, v22, v54
v_mul_f32 v23, v23, v55
v_mul_f32 v24, v24, v56
v_mul_f32 v25, v25, v57
v_mul_f32 v26, v26, v58
v_mul_f32 v27, v27, v59
v_mul_f32 v28, v28, v60
v_mul_f32 v29, v29, v61
v_mul_f32 v30, v30, v62
v_mul_f32 v31, v31, v63
v_cvt_pk_bf16_f32 v48, v16, v17
v_cvt_pk_bf16_f32 v49, v18, v19
v_cvt_pk_bf16_f32 v50, v20, v21
v_cvt_pk_bf16_f32 v51, v22, v23
v_cvt_pk_bf16_f32 v52, v24, v25
v_cvt_pk_bf16_f32 v53, v26, v27
v_cvt_pk_bf16_f32 v54, v28, v29
v_cvt_pk_bf16_f32 v55, v30, v31
ds_write_b128 v8, v[48:51]
ds_write_b128 v8, v[52:55] offset:1024
s_mov_b32 s30, s41
s_mov_b32 s32, s42
s_cmp_lt_u32 s41, 11
s_cbranch_scc1 K2_FLOOP
v_mov_b32 v10, 0xfff1ffe3
s_waitcnt lgkmcnt(0)
ds_write_b32 v5, v10
K2_POLL:
ds_read_b128 v[12:15], v6
s_waitcnt lgkmcnt(0)
v_xor_b32 v12, v12, v10
v_xor_b32 v13, v13, v10
v_xor_b32 v14, v14, v10
v_xor_b32 v15, v15, v10
v_or_b32 v12, v12, v13
v_or3_b32 v12, v12, v14, v15
s_nop 0
v_readfirstlane_b32 s43, v12
s_cmp_eq_u32 s43, 0
s_cbranch_scc1 K2_P2
s_sleep 2
s_branch K2_POLL
K2_P2:
ds_read_b128 v[144:147], v7 offset:0
ds_read_b128 v[148:151], v7 offset:1024
ds_read_b128 v[152:155], v7 offset:2048
ds_read_b128 v[156:159], v7 offset:3072
s_waitcnt lgkmcnt(3)
s_waitcnt vmcnt(15)
v_mfma_f32_32x32x16_bf16 v[16:31], v[64:67], v[144:147], 0
buffer_load_dwordx4 v[64:67], v9, s[36:39], s40 offen offset:0
s_waitcnt vmcnt(15)
v_mfma_f32_32x32x16_bf16 v[32:47], v[68:71], v[144:147], 0
buffer_load_dwordx4 v[68:71], v9, s[36:39], s40 offen offset:1024
s_waitcnt vmcnt(15)
v_mfma_f32_32x32x16_bf16 v[48:63], v[72:75], v[144:147], 0
buffer_load_dwordx4 v[72:75], v9, s[36:39], s40 offen offset:2048
s_waitcnt vmcnt(15)
v_mfma_f32_32x32x16_bf16 v[128:143], v[76:79], v[144:147], 0
buffer_load_dwordx4 v[76:79], v9, s[36:39], s40 offen offset:3072
s_add_u32 s40, s40, 4096
ds_read_b128 v[144:147], v7 offset:4096
s_waitcnt lgkmcnt(3)
s_waitcnt vmcnt(15)
v_mfma_f32_32x32x16_bf16 v[16:31], v[80:83], v[148:151], v[16:31]
buffer_load_dwordx4 v[80:83], v9, s[36:39], s40 offen offset:0
s_waitcnt vmcnt(15)
v_mfma_f32_32x32x16_bf16 v[32:47], v[84:87], v[148:151], v[32:47]
buffer_load_dwordx4 v[84:87], v9, s[36:39], s40 offen offset:1024
s_waitcnt vmcnt(15)
v_mfma_f32_32x32x16_bf16 v[48:63], v[88:91], v[148:151], v[48:63]
buffer_load_dwordx4 v[88:91], v9, s[36:39], s40 offen offset:2048
s_waitcnt vmcnt(15)
v_mfma_f32_32x32x16_bf16 v[128:143], v[92:95], v[148:151], v[128:143]
buffer_load_dwordx4 v[92:95], v9, s[36:39], s40 offen offset:3072
s_add_u32 s40, s40, 4096
ds_read_b128 v[148:151], v7 offset:5120
s_waitcnt lgkmcnt(3)
s_waitcnt vmcnt(15)
v_mfma_f32_32x32x16_bf16 v[16:31], v[96:99], v[152:155], v[16:31]
buffer_load_dwordx4 v[96:99], v9, s[36:39], s40 offen offset:0
s_waitcnt vmcnt(15)
v_mfma_f32_32x32x16_bf16 v[32:47], v[100:103], v[152:155], v[32:47]
buffer_load_dwordx4 v[100:103], v9, s[36:39], s40 offen offset:1024
s_waitcnt vmcnt(15)
v_mfma_f32_32x32x16_bf16 v[48:63], v[104:107], v[152:155], v[48:63]
buffer_load_dwordx4 v[104:107], v9, s[36:39], s40 offen offset:2048
s_waitcnt vmcnt(15)
v_mfma_f32_32x32x16_bf16 v[128:143], v[108:111], v[152:155], v[128:143]
buffer_load_dwordx4 v[108:111], v9, s[36:39], s40 offen offset:3072
s_add_u32 s40, s40, 4096
ds_read_b128 v[152:155], v7 offset:6144
s_waitcnt lgkmcnt(3)
s_waitcnt vmcnt(15)
v_mfma_f32_32x32x16_bf16 v[16:31], v[112:115], v[156:159], v[16:31]
buffer_load_dwordx4 v[112:115], v9, s[36:39], s40 offen offset:0
s_waitcnt vmcnt(15)
v_mfma_f32_32x32x16_bf16 v[32:47], v[116:119], v[156:159], v[32:47]
buffer_load_dwordx4 v[116:119], v9, s[36:39], s40 offen offset:1024
s_waitcnt vmcnt(15)
v_mfma_f32_32x32x16_bf16 v[48:63], v[120:123], v[156:159], v[48:63]
buffer_load_dwordx4 v[120:123], v9, s[36:39], s40 offen offset:2048
s_waitcnt vmcnt(15)
v_mfma_f32_32x32x16_bf16 v[128:143], v[124:127], v[156:159], v[128:143]
buffer_load_dwordx4 v[124:127], v9, s[36:39], s40 offen offset:3072
s_add_u32 s40, s40, 4096
ds_read_b128 v[156:159], v7 offset:7168
s_waitcnt lgkmcnt(3)
s_waitcnt vmcnt(15)
v_mfma_f32_32x32x16_bf16 v[16:31], v[64:67], v[144:147], v[16:31]
buffer_load_dwordx4 v[64:67], v9, s[36:39], s40 offen offset:0
s_waitcnt vmcnt(15)
v_mfma_f32_32x32x16_bf16 v[32:47], v[68:71], v[144:147], v[32:47]
buffer_load_dwordx4 v[68:71], v9, s[36:39], s40 offen offset:1024
s_waitcnt vmcnt(15)
v_mfma_f32_32x32x16_bf16 v[48:63], v[72:75], v[144:147], v[48:63]
buffer_load_dwordx4 v[72:75], v9, s[36:39], s40 offen offset:2048
s_waitcnt vmcnt(15)
v_mfma_f32_32x32x16_bf16 v[128:143], v[76:79], v[144:147], v[128:143]
buffer_load_dwordx4 v[76:79], v9, s[36:39], s40 offen offset:3072
s_add_u32 s40, s40, 4096
ds_read_b128 v[144:147], v7 offset:8192
s_waitcnt lgkmcnt(3)
s_waitcnt vmcnt(15)
v_mfma_f32_32x32x16_bf16 v[16:31], v[80:83], v[148:151], v[16:31]
buffer_load_dwordx4 v[80:83], v9, s[36:39], s40 offen offset:0
s_waitcnt vmcnt(15)
v_mfma_f32_32x32x16_bf16 v[32:47], v[84:87], v[148:151], v[32:47]
buffer_load_dwordx4 v[84:87], v9, s[36:39], s40 offen offset:1024
s_waitcnt vmcnt(15)
v_mfma_f32_32x32x16_bf16 v[48:63], v[88:91], v[148:151], v[48:63]
buffer_load_dwordx4 v[88:91], v9, s[36:39], s40 offen offset:2048
s_waitcnt vmcnt(15)
v_mfma_f32_32x32x16_bf16 v[128:143], v[92:95], v[148:151], v[128:143]
buffer_load_dwordx4 v[92:95], v9, s[36:39], s40 offen offset:3072
s_add_u32 s40, s40, 4096
ds_read_b128 v[148:151], v7 offset:9216
s_waitcnt lgkmcnt(3)
s_waitcnt vmcnt(15)
v_mfma_f32_32x32x16_bf16 v[16:31], v[96:99], v[152:155], v[16:31]
buffer_load_dwordx4 v[96:99], v9, s[36:39], s40 offen offset:0
s_waitcnt vmcnt(15)
v_mfma_f32_32x32x16_bf16 v[32:47], v[100:103], v[152:155], v[32:47]
buffer_load_dwordx4 v[100:103], v9, s[36:39], s40 offen offset:1024
s_waitcnt vmcnt(15)
v_mfma_f32_32x32x16_bf16 v[48:63], v[104:107], v[152:155], v[48:63]
buffer_load_dwordx4 v[104:107], v9, s[36:39], s40 offen offset:2048
s_waitcnt vmcnt(15)
v_mfma_f32_32x32x16_bf16 v[128:143], v[108:111], v[152:155], v[128:143]
buffer_load_dwordx4 v[108:111], v9, s[36:39], s40 offen offset:3072
s_add_u32 s40, s40, 4096
ds_read_b128 v[152:155], v7 offset:10240
s_waitcnt lgkmcnt(3)
s_waitcnt vmcnt(15)
v_mfma_f32_32x32x16_bf16 v[16:31], v[112:115], v[156:159], v[16:31]
buffer_load_dwordx4 v[112:115], v9, s[36:39], s40 offen offset:0
s_waitcnt vmcnt(15)
v_mfma_f32_32x32x16_bf16 v[32:47], v[116:119], v[156:159], v[32:47]
buffer_load_dwordx4 v[116:119], v9, s[36:39], s40 offen offset:1024
s_waitcnt vmcnt(15)
v_mfma_f32_32x32x16_bf16 v[48:63], v[120:123], v[156:159], v[48:63]
buffer_load_dwordx4 v[120:123], v9, s[36:39], s40 offen offset:2048
s_waitcnt vmcnt(15)
v_mfma_f32_32x32x16_bf16 v[128:143], v[124:127], v[156:159], v[128:143]
buffer_load_dwordx4 v[124:127], v9, s[36:39], s40 offen offset:3072
s_add_u32 s40, s40, 4096
ds_read_b128 v[156:159], v7 offset:11264
s_waitcnt lgkmcnt(3)
s_waitcnt vmcnt(15)
v_mfma_f32_32x32x16_bf16 v[16:31], v[64:67], v[144:147], v[16:31]
buffer_load_dwordx4 v[64:67], v9, s[36:39], s40 offen offset:0
s_waitcnt vmcnt(15)
v_mfma_f32_32x32x16_bf16 v[32:47], v[68:71], v[144:147], v[32:47]
buffer_load_dwordx4 v[68:71], v9, s[36:39], s40 offen offset:1024
s_waitcnt vmcnt(15)
v_mfma_f32_32x32x16_bf16 v[48:63], v[72:75], v[144:147], v[48:63]
buffer_load_dwordx4 v[72:75], v9, s[36:39], s40 offen offset:2048
s_waitcnt vmcnt(15)
v_mfma_f32_32x32x16_bf16 v[128:143], v[76:79], v[144:147], v[128:143]
buffer_load_dwordx4 v[76:79], v9, s[36:39], s40 offen offset:3072
s_add_u32 s40, s40, 4096
ds_read_b128 v[144:147], v7 offset:12288
s_waitcnt lgkmcnt(3)
s_waitcnt vmcnt(15)
v_mfma_f32_32x32x16_bf16 v[16:31], v[80:83], v[148:151], v[16:31]
buffer_load_dwordx4 v[80:83], v9, s[36:39], s40 offen offset:0
s_waitcnt vmcnt(15)
v_mfma_f32_32x32x16_bf16 v[32:47], v[84:87], v[148:151], v[32:47]
buffer_load_dwordx4 v[84:87], v9, s[36:39], s40 offen offset:1024
s_waitcnt vmcnt(15)
v_mfma_f32_32x32x16_bf16 v[48:63], v[88:91], v[148:151], v[48:63]
buffer_load_dwordx4 v[88:91], v9, s[36:39], s40 offen offset:2048
s_waitcnt vmcnt(15)
v_mfma_f32_32x32x16_bf16 v[128:143], v[92:95], v[148:151], v[128:143]
buffer_load_dwordx4 v[92:95], v9, s[36:39], s40 offen offset:3072
s_add_u32 s40, s40, 4096
ds_read_b128 v[148:151], v7 offset:13312
s_waitcnt lgkmcnt(3)
s_waitcnt vmcnt(15)
v_mfma_f32_32x32x16_bf16 v[16:31], v[96:99], v[152:155], v[16:31]
buffer_load_dwordx4 v[96:99], v9, s[36:39], s40 offen offset:0
s_waitcnt vmcnt(15)
v_mfma_f32_32x32x16_bf16 v[32:47], v[100:103], v[152:155], v[32:47]
buffer_load_dwordx4 v[100:103], v9, s[36:39], s40 offen offset:1024
s_waitcnt vmcnt(15)
v_mfma_f32_32x32x16_bf16 v[48:63], v[104:107], v[152:155], v[48:63]
buffer_load_dwordx4 v[104:107], v9, s[36:39], s40 offen offset:2048
s_waitcnt vmcnt(15)
v_mfma_f32_32x32x16_bf16 v[128:143], v[108:111], v[152:155], v[128:143]
buffer_load_dwordx4 v[108:111], v9, s[36:39], s40 offen offset:3072
s_add_u32 s40, s40, 4096
ds_read_b128 v[152:155], v7 offset:14336
s_waitcnt lgkmcnt(3)
s_waitcnt vmcnt(15)
v_mfma_f32_32x32x16_bf16 v[16:31], v[112:115], v[156:159], v[16:31]
buffer_load_dwordx4 v[112:115], v9, s[36:39], s40 offen offset:0
s_waitcnt vmcnt(15)
v_mfma_f32_32x32x16_bf16 v[32:47], v[116:119], v[156:159], v[32:47]
buffer_load_dwordx4 v[116:119], v9, s[36:39], s40 offen offset:1024
s_waitcnt vmcnt(15)
v_mfma_f32_32x32x16_bf16 v[48:63], v[120:123], v[156:159], v[48:63]
buffer_load_dwordx4 v[120:123], v9, s[36:39], s40 offen offset:2048
s_waitcnt vmcnt(15)
v_mfma_f32_32x32x16_bf16 v[128:143], v[124:127], v[156:159], v[128:143]
buffer_load_dwordx4 v[124:127], v9, s[36:39], s40 offen offset:3072
s_add_u32 s40, s40, 4096
ds_read_b128 v[156:159], v7 offset:15360
s_waitcnt lgkmcnt(3)
s_waitcnt vmcnt(15)
v_mfma_f32_32x32x16_bf16 v[16:31], v[64:67], v[144:147], v[16:31]
buffer_load_dwordx4 v[64:67], v9, s[36:39], s40 offen offset:0
s_waitcnt vmcnt(15)
v_mfma_f32_32x32x16_bf16 v[32:47], v[68:71], v[144:147], v[32:47]
buffer_load_dwordx4 v[68:71], v9, s[36:39], s40 offen offset:1024
s_waitcnt vmcnt(15)
v_mfma_f32_32x32x16_bf16 v[48:63], v[72:75], v[144:147], v[48:63]
buffer_load_dwordx4 v[72:75], v9, s[36:39], s40 offen offset:2048
s_waitcnt vmcnt(15)
v_mfma_f32_32x32x16_bf16 v[128:143], v[76:79], v[144:147], v[128:143]
buffer_load_dwordx4 v[76:79], v9, s[36:39], s40 offen offset:3072
s_add_u32 s40, s40, 4096
ds_read_b128 v[144:147], v7 offset:16384
s_waitcnt lgkmcnt(3)
s_waitcnt vmcnt(15)
v_mfma_f32_32x32x16_bf16 v[16:31], v[80:83], v[148:151], v[16:31]
buffer_load_dwordx4 v[80:83], v9, s[36:39], s40 offen offset:0
s_waitcnt vmcnt(15)
v_mfma_f32_32x32x16_bf16 v[32:47], v[84:87], v[148:151], v[32:47]
buffer_load_dwordx4 v[84:87], v9, s[36:39], s40 offen offset:1024
s_waitcnt vmcnt(15)
v_mfma_f32_32x32x16_bf16 v[48:63], v[88:91], v[148:151], v[48:63]
buffer_load_dwordx4 v[88:91], v9, s[36:39], s40 offen offset:2048
s_waitcnt vmcnt(15)
v_mfma_f32_32x32x16_bf16 v[128:143], v[92:95], v[148:151], v[128:143]
buffer_load_dwordx4 v[92:95], v9, s[36:39], s40 offen offset:3072
s_add_u32 s40, s40, 4096
ds_read_b128 v[148:151], v7 offset:17408
s_waitcnt lgkmcnt(3)
s_waitcnt vmcnt(15)
v_mfma_f32_32x32x16_bf16 v[16:31], v[96:99], v[152:155], v[16:31]
buffer_load_dwordx4 v[96:99], v9, s[36:39], s40 offen offset:0
s_waitcnt vmcnt(15)
v_mfma_f32_32x32x16_bf16 v[32:47], v[100:103], v[152:155], v[32:47]
buffer_load_dwordx4 v[100:103], v9, s[36:39], s40 offen offset:1024
s_waitcnt vmcnt(15)
v_mfma_f32_32x32x16_bf16 v[48:63], v[104:107], v[152:155], v[48:63]
buffer_load_dwordx4 v[104:107], v9, s[36:39], s40 offen offset:2048
s_waitcnt vmcnt(15)
v_mfma_f32_32x32x16_bf16 v[128:143], v[108:111], v[152:155], v[128:143]
buffer_load_dwordx4 v[108:111], v9, s[36:39], s40 offen offset:3072
s_add_u32 s40, s40, 4096
ds_read_b128 v[152:155], v7 offset:18432
s_waitcnt lgkmcnt(3)
s_waitcnt vmcnt(15)
v_mfma_f32_32x32x16_bf16 v[16:31], v[112:115], v[156:159], v[16:31]
buffer_load_dwordx4 v[112:115], v9, s[36:39], s40 offen offset:0
s_waitcnt vmcnt(15)
v_mfma_f32_32x32x16_bf16 v[32:47], v[116:119], v[156:159], v[32:47]
buffer_load_dwordx4 v[116:119], v9, s[36:39], s40 offen offset:1024
s_waitcnt vmcnt(15)
v_mfma_f32_32x32x16_bf16 v[48:63], v[120:123], v[156:159], v[48:63]
buffer_load_dwordx4 v[120:123], v9, s[36:39], s40 offen offset:2048
s_waitcnt vmcnt(15)
v_mfma_f32_32x32x16_bf16 v[128:143], v[124:127], v[156:159], v[128:143]
buffer_load_dwordx4 v[124:127], v9, s[36:39], s40 offen offset:3072
s_add_u32 s40, s40, 4096
ds_read_b128 v[156:159], v7 offset:19456
s_waitcnt lgkmcnt(3)
s_waitcnt vmcnt(15)
v_mfma_f32_32x32x16_bf16 v[16:31], v[64:67], v[144:147], v[16:31]
buffer_load_dwordx4 v[64:67], v9, s[36:39], s40 offen offset:0
s_waitcnt vmcnt(15)
v_mfma_f32_32x32x16_bf16 v[32:47], v[68:71], v[144:147], v[32:47]
buffer_load_dwordx4 v[68:71], v9, s[36:39], s40 offen offset:1024
s_waitcnt vmcnt(15)
v_mfma_f32_32x32x16_bf16 v[48:63], v[72:75], v[144:147], v[48:63]
buffer_load_dwordx4 v[72:75], v9, s[36:39], s40 offen offset:2048
s_waitcnt vmcnt(15)
v_mfma_f32_32x32x16_bf16 v[128:143], v[76:79], v[144:147], v[128:143]
buffer_load_dwordx4 v[76:79], v9, s[36:39], s40 offen offset:3072
s_add_u32 s40, s40, 4096
ds_read_b128 v[144:147], v7 offset:20480
s_waitcnt lgkmcnt(3)
s_waitcnt vmcnt(15)
v_mfma_f32_32x32x16_bf16 v[16:31], v[80:83], v[148:151], v[16:31]
buffer_load_dwordx4 v[80:83], v9, s[36:39], s40 offen offset:0
s_waitcnt vmcnt(15)
v_mfma_f32_32x32x16_bf16 v[32:47], v[84:87], v[148:151], v[32:47]
buffer_load_dwordx4 v[84:87], v9, s[36:39], s40 offen offset:1024
s_waitcnt vmcnt(15)
v_mfma_f32_32x32x16_bf16 v[48:63], v[88:91], v[148:151], v[48:63]
buffer_load_dwordx4 v[88:91], v9, s[36:39], s40 offen offset:2048
s_waitcnt vmcnt(15)
v_mfma_f32_32x32x16_bf16 v[128:143], v[92:95], v[148:151], v[128:143]
buffer_load_dwordx4 v[92:95], v9, s[36:39], s40 offen offset:3072
s_add_u32 s40, s40, 4096
ds_read_b128 v[148:151], v7 offset:21504
s_waitcnt lgkmcnt(3)
s_waitcnt vmcnt(15)
v_mfma_f32_32x32x16_bf16 v[16:31], v[96:99], v[152:155], v[16:31]
s_mov_b32 s40, s34
buffer_load_dwordx4 v[96:99], v9, s[36:39], s40 offen offset:0
s_waitcnt vmcnt(15)
v_mfma_f32_32x32x16_bf16 v[32:47], v[100:103], v[152:155], v[32:47]
buffer_load_dwordx4 v[100:103], v9, s[36:39], s40 offen offset:1024
s_waitcnt vmcnt(15)
v_mfma_f32_32x32x16_bf16 v[48:63], v[104:107], v[152:155], v[48:63]
buffer_load_dwordx4 v[104:107], v9, s[36:39], s40 offen offset:2048
s_waitcnt vmcnt(15)
v_mfma_f32_32x32x16_bf16 v[128:143], v[108:111], v[152:155], v[128:143]
buffer_load_dwordx4 v[108:111], v9, s[36:39], s40 offen offset:3072
s_add_u32 s40, s40, 4096
s_waitcnt lgkmcnt(2)
s_waitcnt vmcnt(15)
v_mfma_f32_32x32x16_bf16 v[16:31], v[112:115], v[156:159], v[16:31]
buffer_load_dwordx4 v[112:115], v9, s[36:39], s40 offen offset:0
s_waitcnt vmcnt(15)
v_mfma_f32_32x32x16_bf16 v[32:47], v[116:119], v[156:159], v[32:47]
buffer_load_dwordx4 v[116:119], v9, s[36:39], s40 offen offset:1024
s_waitcnt vmcnt(15)
v_mfma_f32_32x32x16_bf16 v[48:63], v[120:123], v[156:159], v[48:63]
buffer_load_dwordx4 v[120:123], v9, s[36:39], s40 offen offset:2048
s_waitcnt vmcnt(15)
v_mfma_f32_32x32x16_bf16 v[128:143], v[124:127], v[156:159], v[128:143]
buffer_load_dwordx4 v[124:127], v9, s[36:39], s40 offen offset:3072
s_add_u32 s40, s40, 4096
s_waitcnt lgkmcnt(1)
s_waitcnt vmcnt(15)
v_mfma_f32_32x32x16_bf16 v[16:31], v[64:67], v[144:147], v[16:31]
buffer_load_dwordx4 v[64:67], v9, s[36:39], s40 offen offset:0
s_waitcnt vmcnt(15)
v_mfma_f32_32x32x16_bf16 v[32:47], v[68:71], v[144:147], v[32:47]
buffer_load_dwordx4 v[68:71], v9, s[36:39], s40 offen offset:1024
s_waitcnt vmcnt(15)
v_mfma_f32_32x32x16_bf16 v[48:63], v[72:75], v[144:147], v[48:63]
buffer_load_dwordx4 v[72:75], v9, s[36:39], s40 offen offset:2048
s_waitcnt vmcnt(15)
v_mfma_f32_32x32x16_bf16 v[128:143], v[76:79], v[144:147], v[128:143]
buffer_load_dwordx4 v[76:79], v9, s[36:39], s40 offen offset:3072
s_add_u32 s40, s40, 4096
s_waitcnt lgkmcnt(0)
s_waitcnt vmcnt(15)
v_mfma_f32_32x32x16_bf16 v[16:31], v[80:83], v[148:151], v[16:31]
buffer_load_dwordx4 v[80:83], v9, s[36:39], s40 offen offset:0
s_waitcnt vmcnt(15)
v_mfma_f32_32x32x16_bf16 v[32:47], v[84:87], v[148:151], v[32:47]
buffer_load_dwordx4 v[84:87], v9, s[36:39], s40 offen offset:1024
s_waitcnt vmcnt(15)
v_mfma_f32_32x32x16_bf16 v[48:63], v[88:91], v[148:151], v[48:63]
buffer_load_dwordx4 v[88:91], v9, s[36:39], s40 offen offset:2048
s_waitcnt vmcnt(15)
v_mfma_f32_32x32x16_bf16 v[128:143], v[92:95], v[148:151], v[128:143]
buffer_load_dwordx4 v[92:95], v9, s[36:39], s40 offen offset:3072
s_add_u32 s40, s40, 4096
buffer_load_dwordx4 v[160:163], v9, s[36:39], s40 offen offset:0
buffer_load_dwordx4 v[164:167], v9, s[36:39], s40 offen offset:1024
buffer_load_dwordx4 v[168:171], v9, s[36:39], s40 offen offset:2048
buffer_load_dwordx4 v[172:175], v9, s[36:39], s40 offen offset:3072
s_add_u32 s40, s40, 4096
buffer_load_dwordx4 v[176:179], v9, s[36:39], s40 offen offset:0
buffer_load_dwordx4 v[180:183], v9, s[36:39], s40 offen offset:1024
buffer_load_dwordx4 v[184:187], v9, s[36:39], s40 offen offset:2048
buffer_load_dwordx4 v[188:191], v9, s[36:39], s40 offen offset:3072
s_add_u32 s40, s40, 4096
buffer_load_dwordx4 v[192:195], v9, s[36:39], s40 offen offset:0
buffer_load_dwordx4 v[196:199], v9, s[36:39], s40 offen offset:1024
buffer_load_dwordx4 v[200:203], v9, s[36:39], s40 offen offset:2048
buffer_load_dwordx4 v[204:207], v9, s[36:39], s40 offen offset:3072
s_add_u32 s40, s40, 4096
buffer_load_dwordx4 v[208:211], v9, s[36:39], s40 offen offset:0
buffer_load_dwordx4 v[212:215], v9, s[36:39], s40 offen offset:1024
buffer_load_dwordx4 v[216:219], v9, s[36:39], s40 offen offset:2048
buffer_load_dwordx4 v[220:223], v9, s[36:39], s40 offen offset:3072
s_add_u32 s40, s40, 4096
v_add_u32 v8, 153600, v9
s_lshl_b32 s28, s26, 21
s_add_u32 s28, s28, s27
s_lshl_b32 s29, s24, 13
s_add_u32 s28, s28, s29
s_add_u32 s28, s28, 12582912
s_add_u32 s29, s28, 4096
v_lshlrev_b32 v1, 10, v2
v_lshl_add_u32 v1, v3, 4, v1
s_lshl_b32 s41, s24, 8
s_add_u32 s41, s41, s27
s_lshl_b32 s45, s26, 6
s_add_u32 s47, s45, s41
s_mov_b32 s48, s4
s_mov_b32 s49, s5
s_mov_b32 s50, 2097152
s_mov_b32 s51, 0x00020000
s_mov_b32 s52, s6
s_mov_b32 s53, s7
s_mov_b32 s54, 2097152
s_mov_b32 s55, 0x00020000
buffer_load_dwordx4 v[4:7], v1, s[48:51], s47 offen
buffer_load_dwordx4 v[12:15], v1, s[48:51], s47 offen offset:32
s_waitcnt vmcnt(0)
s_barrier
ds_read_b128 v[224:227], v8 offset:0
ds_read_b128 v[228:231], v8 offset:1024
ds_read_b128 v[232:235], v8 offset:2048
ds_read_b128 v[236:239], v8 offset:3072
ds_read_b128 v[240:243], v8 offset:4096
ds_read_b128 v[244:247], v8 offset:5120
ds_read_b128 v[248:251], v8 offset:6144
ds_read_b128 v[252:255], v8 offset:7168
s_waitcnt lgkmcnt(7)
v_mfma_f32_32x32x16_bf16 v[16:31], v[96:99], v[224:227], v[16:31]
s_waitcnt lgkmcnt(6)
v_mfma_f32_32x32x16_bf16 v[16:31], v[112:115], v[228:231], v[16:31]
s_waitcnt lgkmcnt(5)
v_mfma_f32_32x32x16_bf16 v[16:31], v[64:67], v[232:235], v[16:31]
s_waitcnt lgkmcnt(4)
v_mfma_f32_32x32x16_bf16 v[16:31], v[80:83], v[236:239], v[16:31]
s_waitcnt lgkmcnt(3)
v_mfma_f32_32x32x16_bf16 v[16:31], v[160:163], v[240:243], v[16:31]
s_waitcnt lgkmcnt(2)
v_mfma_f32_32x32x16_bf16 v[16:31], v[176:179], v[244:247], v[16:31]
s_waitcnt lgkmcnt(1)
v_mfma_f32_32x32x16_bf16 v[16:31], v[192:195], v[248:251], v[16:31]
s_waitcnt lgkmcnt(0)
v_mfma_f32_32x32x16_bf16 v[16:31], v[208:211], v[252:255], v[16:31]
v_mfma_f32_32x32x16_bf16 v[32:47], v[100:103], v[224:227], v[32:47]
v_mfma_f32_32x32x16_bf16 v[32:47], v[116:119], v[228:231], v[32:47]
v_mfma_f32_32x32x16_bf16 v[32:47], v[68:71], v[232:235], v[32:47]
v_mfma_f32_32x32x16_bf16 v[32:47], v[84:87], v[236:239], v[32:47]
v_mfma_f32_32x32x16_bf16 v[32:47], v[164:167], v[240:243], v[32:47]
v_mfma_f32_32x32x16_bf16 v[32:47], v[180:183], v[244:247], v[32:47]
v_mfma_f32_32x32x16_bf16 v[32:47], v[196:199], v[248:251], v[32:47]
v_mfma_f32_32x32x16_bf16 v[32:47], v[212:215], v[252:255], v[32:47]
v_mfma_f32_32x32x16_bf16 v[48:63], v[104:107], v[224:227], v[48:63]
v_mfma_f32_32x32x16_bf16 v[48:63], v[120:123], v[228:231], v[48:63]
v_mfma_f32_32x32x16_bf16 v[48:63], v[72:75], v[232:235], v[48:63]
v_mfma_f32_32x32x16_bf16 v[48:63], v[88:91], v[236:239], v[48:63]
v_mfma_f32_32x32x16_bf16 v[48:63], v[168:171], v[240:243], v[48:63]
v_mfma_f32_32x32x16_bf16 v[48:63], v[184:187], v[244:247], v[48:63]
v_mfma_f32_32x32x16_bf16 v[48:63], v[200:203], v[248:251], v[48:63]
v_mfma_f32_32x32x16_bf16 v[48:63], v[216:219], v[252:255], v[48:63]
v_mfma_f32_32x32x16_bf16 v[128:143], v[108:111], v[224:227], v[128:143]
v_mfma_f32_32x32x16_bf16 v[128:143], v[124:127], v[228:231], v[128:143]
v_mfma_f32_32x32x16_bf16 v[128:143], v[76:79], v[232:235], v[128:143]
v_mfma_f32_32x32x16_bf16 v[128:143], v[92:95], v[236:239], v[128:143]
v_mfma_f32_32x32x16_bf16 v[128:143], v[172:175], v[240:243], v[128:143]
v_mfma_f32_32x32x16_bf16 v[128:143], v[188:191], v[244:247], v[128:143]
v_mfma_f32_32x32x16_bf16 v[128:143], v[204:207], v[248:251], v[128:143]
v_mfma_f32_32x32x16_bf16 v[128:143], v[220:223], v[252:255], v[128:143]
v_cvt_pk_bf16_f32 v16, v16, v17
v_cvt_pk_bf16_f32 v17, v18, v19
v_cvt_pk_bf16_f32 v18, v20, v21
v_cvt_pk_bf16_f32 v19, v22, v23
v_cvt_pk_bf16_f32 v20, v24, v25
v_cvt_pk_bf16_f32 v21, v26, v27
v_cvt_pk_bf16_f32 v22, v28, v29
v_cvt_pk_bf16_f32 v23, v30, v31
s_nop 1
v_permlane32_swap_b32 v16, v18
v_permlane32_swap_b32 v17, v19
v_permlane32_swap_b32 v20, v22
v_permlane32_swap_b32 v21, v23
buffer_store_dwordx4 v[16:19], v9, s[36:39], s28 offen offset:0 sc1
buffer_store_dwordx4 v[20:23], v9, s[36:39], s28 offen offset:1024 sc1
v_cvt_pk_bf16_f32 v32, v32, v33
v_cvt_pk_bf16_f32 v33, v34, v35
v_cvt_pk_bf16_f32 v34, v36, v37
v_cvt_pk_bf16_f32 v35, v38, v39
v_cvt_pk_bf16_f32 v36, v40, v41
v_cvt_pk_bf16_f32 v37, v42, v43
v_cvt_pk_bf16_f32 v38, v44, v45
v_cvt_pk_bf16_f32 v39, v46, v47
s_nop 1
v_permlane32_swap_b32 v32, v34
v_permlane32_swap_b32 v33, v35
v_permlane32_swap_b32 v36, v38
v_permlane32_swap_b32 v37, v39
buffer_store_dwordx4 v[32:35], v9, s[36:39], s28 offen offset:2048 sc1
buffer_store_dwordx4 v[36:39], v9, s[36:39], s28 offen offset:3072 sc1
v_cvt_pk_bf16_f32 v48, v48, v49
v_cvt_pk_bf16_f32 v49, v50, v51
v_cvt_pk_bf16_f32 v50, v52, v53
v_cvt_pk_bf16_f32 v51, v54, v55
v_cvt_pk_bf16_f32 v52, v56, v57
v_cvt_pk_bf16_f32 v53, v58, v59
v_cvt_pk_bf16_f32 v54, v60, v61
v_cvt_pk_bf16_f32 v55, v62, v63
s_nop 1
v_permlane32_swap_b32 v48, v50
v_permlane32_swap_b32 v49, v51
v_permlane32_swap_b32 v52, v54
v_permlane32_swap_b32 v53, v55
buffer_store_dwordx4 v[48:51], v9, s[36:39], s29 offen offset:0 sc1
buffer_store_dwordx4 v[52:55], v9, s[36:39], s29 offen offset:1024 sc1
s_nop 7
v_cvt_pk_bf16_f32 v128, v128, v129
v_cvt_pk_bf16_f32 v129, v130, v131
v_cvt_pk_bf16_f32 v130, v132, v133
v_cvt_pk_bf16_f32 v131, v134, v135
v_cvt_pk_bf16_f32 v132, v136, v137
v_cvt_pk_bf16_f32 v133, v138, v139
v_cvt_pk_bf16_f32 v134, v140, v141
v_cvt_pk_bf16_f32 v135, v142, v143
s_nop 1
v_permlane32_swap_b32 v128, v130
v_permlane32_swap_b32 v129, v131
v_permlane32_swap_b32 v132, v134
v_permlane32_swap_b32 v133, v135
buffer_store_dwordx4 v[128:131], v9, s[36:39], s29 offen offset:2048 sc1
buffer_store_dwordx4 v[132:135], v9, s[36:39], s29 offen offset:3072 sc1
s_lshl_b32 s40, s25, 8
s_lshl_b32 s45, s24, 6
s_add_u32 s40, s40, s45
s_add_u32 s40, s40, 4390912
v_mov_b32 v10, 0
v_mov_b32 v11, 1
s_lshl_b32 s29, s24, 13
s_add_u32 s28, s27, s29
s_add_u32 s28, s28, 12582912
s_mov_b64 exec, 1
s_waitcnt vmcnt(0)
buffer_atomic_add v11, v10, s[36:39], s40 offen sc0
s_waitcnt vmcnt(0)
v_readfirstlane_b32 s42, v11
s_lshl_b32 s43, 1, s26
s_and_b32 s45, s42, 0xff
s_bfe_u32 s46, s42, 0x40008
s_or_b32 s46, s46, s43
s_cmp_eq_u32 s45, 3
s_cselect_b32 s43, s46, s43
s_cbranch_scc1 K2_WORK
s_mov_b32 s44, 0
K2_SPIN:
s_cmp_ge_u32 s44, 64
s_cbranch_scc1 K2_ABN
v_mov_b32 v11, 0
buffer_atomic_add v11, v10, s[36:39], s40 offen sc0
s_add_u32 s44, s44, 1
s_waitcnt vmcnt(0)
v_readfirstlane_b32 s42, v11
s_and_b32 s45, s42, 0xff
s_cmp_eq_u32 s45, 4
s_cbranch_scc1 K2_WORK
s_branch K2_SPIN
K2_ABN:
s_lshl_b32 s45, s43, 8
v_mov_b32 v11, s45
buffer_atomic_add v11, v10, s[36:39], s40 offen sc0
s_waitcnt vmcnt(0)
v_readfirstlane_b32 s42, v11
s_and_b32 s45, s42, 0xff
s_cmp_lg_u32 s45, 4
s_cbranch_scc1 K2_NL
K2_WORK:
s_mov_b64 exec, -1
s_mov_b32 s44, s26
K2_W2:
s_bitset0_b32 s43, s44
s_lshl_b32 s46, s44, 11
s_add_u32 s46, s46, s28
buffer_load_dwordx4 v[64:67], v9, s[36:39], s46 offen offset:0 sc1
buffer_load_dwordx4 v[80:83], v9, s[36:39], s46 offen offset:1024 sc1
s_add_u32 s46, s46, 2097152
buffer_load_dwordx4 v[68:71], v9, s[36:39], s46 offen offset:0 sc1
buffer_load_dwordx4 v[84:87], v9, s[36:39], s46 offen offset:1024 sc1
s_add_u32 s46, s46, 2097152
buffer_load_dwordx4 v[72:75], v9, s[36:39], s46 offen offset:0 sc1
buffer_load_dwordx4 v[88:91], v9, s[36:39], s46 offen offset:1024 sc1
s_add_u32 s46, s46, 2097152
buffer_load_dwordx4 v[76:79], v9, s[36:39], s46 offen offset:0 sc1
buffer_load_dwordx4 v[92:95], v9, s[36:39], s46 offen offset:1024 sc1
s_add_u32 s46, s46, 2097152
s_waitcnt vmcnt(6)
v_lshlrev_b32 v32, 16, v64
v_and_b32 v33, 0xffff0000, v64
v_lshlrev_b32 v34, 16, v65
v_and_b32 v35, 0xffff0000, v65
v_lshlrev_b32 v36, 16, v66
v_and_b32 v37, 0xffff0000, v66
v_lshlrev_b32 v38, 16, v67
v_and_b32 v39, 0xffff0000, v67
v_lshlrev_b32 v40, 16, v80
v_and_b32 v41, 0xffff0000, v80
v_lshlrev_b32 v42, 16, v81
v_and_b32 v43, 0xffff0000, v81
v_lshlrev_b32 v44, 16, v82
v_and_b32 v45, 0xffff0000, v82
v_lshlrev_b32 v46, 16, v83
v_and_b32 v47, 0xffff0000, v83
s_waitcnt vmcnt(4)
v_lshlrev_b32 v56, 16, v68
v_and_b32 v57, 0xffff0000, v68
v_add_f32 v32, v32, v56
v_add_f32 v33, v33, v57
v_lshlrev_b32 v56, 16, v69
v_and_b32 v57, 0xffff0000, v69
v_add_f32 v34, v34, v56
v_add_f32 v35, v35, v57
v_lshlrev_b32 v56, 16, v70
v_and_b32 v57, 0xffff0000, v70
v_add_f32 v36, v36, v56
v_add_f32 v37, v37, v57
v_lshlrev_b32 v56, 16, v71
v_and_b32 v57, 0xffff0000, v71
v_add_f32 v38, v38, v56
v_add_f32 v39, v39, v57
v_lshlrev_b32 v56, 16, v84
v_and_b32 v57, 0xffff0000, v84
v_add_f32 v40, v40, v56
v_add_f32 v41, v41, v57
v_lshlrev_b32 v56, 16, v85
v_and_b32 v57, 0xffff0000, v85
v_add_f32 v42, v42, v56
v_add_f32 v43, v43, v57
v_lshlrev_b32 v56, 16, v86
v_and_b32 v57, 0xffff0000, v86
v_add_f32 v44, v44, v56
v_add_f32 v45, v45, v57
v_lshlrev_b32 v56, 16, v87
v_and_b32 v57, 0xffff0000, v87
v_add_f32 v46, v46, v56
v_add_f32 v47, v47, v57
s_waitcnt vmcnt(2)
v_lshlrev_b32 v56, 16, v72
v_and_b32 v57, 0xffff0000, v72
v_add_f32 v32, v32, v56
v_add_f32 v33, v33, v57
v_lshlrev_b32 v56, 16, v73
v_and_b32 v57, 0xffff0000, v73
v_add_f32 v34, v34, v56
v_add_f32 v35, v35, v57
v_lshlrev_b32 v56, 16, v74
v_and_b32 v57, 0xffff0000, v74
v_add_f32 v36, v36, v56
v_add_f32 v37, v37, v57
v_lshlrev_b32 v56, 16, v75
v_and_b32 v57, 0xffff0000, v75
v_add_f32 v38, v38, v56
v_add_f32 v39, v39, v57
v_lshlrev_b32 v56, 16, v88
v_and_b32 v57, 0xffff0000, v88
v_add_f32 v40, v40, v56
v_add_f32 v41, v41, v57
v_lshlrev_b32 v56, 16, v89
v_and_b32 v57, 0xffff0000, v89
v_add_f32 v42, v42, v56
v_add_f32 v43, v43, v57
v_lshlrev_b32 v56, 16, v90
v_and_b32 v57, 0xffff0000, v90
v_add_f32 v44, v44, v56
v_add_f32 v45, v45, v57
v_lshlrev_b32 v56, 16, v91
v_and_b32 v57, 0xffff0000, v91
v_add_f32 v46, v46, v56
v_add_f32 v47, v47, v57
s_waitcnt vmcnt(0)
v_lshlrev_b32 v56, 16, v76
v_and_b32 v57, 0xffff0000, v76
v_add_f32 v32, v32, v56
v_add_f32 v33, v33, v57
v_lshlrev_b32 v56, 16, v77
v_and_b32 v57, 0xffff0000, v77
v_add_f32 v34, v34, v56
v_add_f32 v35, v35, v57
v_lshlrev_b32 v56, 16, v78
v_and_b32 v57, 0xffff0000, v78
v_add_f32 v36, v36, v56
v_add_f32 v37, v37, v57
v_lshlrev_b32 v56, 16, v79
v_and_b32 v57, 0xffff0000, v79
v_add_f32 v38, v38, v56
v_add_f32 v39, v39, v57
v_lshlrev_b32 v56, 16, v92
v_and_b32 v57, 0xffff0000, v92
v_add_f32 v40, v40, v56
v_add_f32 v41, v41, v57
v_lshlrev_b32 v56, 16, v93
v_and_b32 v57, 0xffff0000, v93
v_add_f32 v42, v42, v56
v_add_f32 v43, v43, v57
v_lshlrev_b32 v56, 16, v94
v_and_b32 v57, 0xffff0000, v94
v_add_f32 v44, v44, v56
v_add_f32 v45, v45, v57
v_lshlrev_b32 v56, 16, v95
v_and_b32 v57, 0xffff0000, v95
v_add_f32 v46, v46, v56
v_add_f32 v47, v47, v57
v_lshlrev_b32 v56, 16, v4
v_and_b32 v57, 0xffff0000, v4
v_add_f32 v32, v32, v56
v_add_f32 v33, v33, v57
v_cvt_pk_bf16_f32 v4, v32, v33
v_lshlrev_b32 v56, 16, v5
v_and_b32 v57, 0xffff0000, v5
v_add_f32 v34, v34, v56
v_add_f32 v35, v35, v57
v_cvt_pk_bf16_f32 v5, v34, v35
v_lshlrev_b32 v56, 16, v6
v_and_b32 v57, 0xffff0000, v6
v_add_f32 v36, v36, v56
v_add_f32 v37, v37, v57
v_cvt_pk_bf16_f32 v6, v36, v37
v_lshlrev_b32 v56, 16, v7
v_and_b32 v57, 0xffff0000, v7
v_add_f32 v38, v38, v56
v_add_f32 v39, v39, v57
v_cvt_pk_bf16_f32 v7, v38, v39
buffer_store_dwordx4 v[4:7], v1, s[52:55], s47 offen offset:0
v_lshlrev_b32 v56, 16, v12
v_and_b32 v57, 0xffff0000, v12
v_add_f32 v40, v40, v56
v_add_f32 v41, v41, v57
v_cvt_pk_bf16_f32 v12, v40, v41
v_lshlrev_b32 v56, 16, v13
v_and_b32 v57, 0xffff0000, v13
v_add_f32 v42, v42, v56
v_add_f32 v43, v43, v57
v_cvt_pk_bf16_f32 v13, v42, v43
v_lshlrev_b32 v56, 16, v14
v_and_b32 v57, 0xffff0000, v14
v_add_f32 v44, v44, v56
v_add_f32 v45, v45, v57
v_cvt_pk_bf16_f32 v14, v44, v45
v_lshlrev_b32 v56, 16, v15
v_and_b32 v57, 0xffff0000, v15
v_add_f32 v46, v46, v56
v_add_f32 v47, v47, v57
v_cvt_pk_bf16_f32 v15, v46, v47
buffer_store_dwordx4 v[12:15], v1, s[52:55], s47 offen offset:32
s_cmp_eq_u32 s43, 0
s_cbranch_scc1 K2_NL
s_ff1_i32_b32 s44, s43
s_lshl_b32 s47, s44, 6
s_add_u32 s47, s47, s41
s_waitcnt vmcnt(0)
buffer_load_dwordx4 v[4:7], v1, s[48:51], s47 offen
buffer_load_dwordx4 v[12:15], v1, s[48:51], s47 offen offset:32
s_waitcnt vmcnt(0)
s_branch K2_W2
K2_NL:
s_add_u32 s24, s24, 4
K2_END:
s_endpgm
.section .rodata,"a"
.p2align 6
.amdhsa_kernel prep_kernel
  .amdhsa_next_free_vgpr 256
  .amdhsa_next_free_sgpr 96
  .amdhsa_accum_offset 256
  .amdhsa_group_segment_fixed_size 0
  .amdhsa_kernarg_size 96
  .amdhsa_user_sgpr_count 2
  .amdhsa_user_sgpr_kernarg_segment_ptr 1
  .amdhsa_system_sgpr_workgroup_id_x 1
.end_amdhsa_kernel
.section .rodata,"a"
.p2align 6
.amdhsa_kernel main_kernel
  .amdhsa_next_free_vgpr 256
  .amdhsa_next_free_sgpr 96
  .amdhsa_accum_offset 256
  .amdhsa_group_segment_fixed_size 0
  .amdhsa_kernarg_size 96
  .amdhsa_user_sgpr_count 2
  .amdhsa_user_sgpr_kernarg_segment_ptr 1
  .amdhsa_system_sgpr_workgroup_id_x 1
.end_amdhsa_kernel
```
